```python
import torch

def _softmax(x, axis=-1):
    return torch.softmax(x, dim=axis)
def _gelu(x):
    return torch.nn.functional.gelu(x, approximate="tanh")
def _silu(x):
    return torch.nn.functional.silu(x)
def _sigmoid(x):
    return torch.sigmoid(x)
def _layernorm(x, axis=-1, eps=1e-5):
    m = x.mean(dim=axis, keepdim=True)
    v = x.var(dim=axis, keepdim=True, unbiased=False)
    return (x - m) / torch.sqrt(v + eps)
def _scatter_add(tgt, idx, src, axis=0):
    return tgt.clone().index_add_(axis, idx, src)
def _segment_sum(src, seg, n):
    out = torch.zeros((n,) + src.shape[1:], dtype=src.dtype)
    return out.index_add_(0, seg, src)
def _pad(x, pw):
    flat = tuple(v for pair in reversed(pw) for v in pair)
    return torch.nn.functional.pad(x, flat)

kernel_name = 'concat_heads__linear_kernel_hedgehog__spectral_fnet__prompt'

def setup_inputs():

    _w = (lambda a: (lambda t: t.to(torch.bfloat16) if t.is_floating_point() else t)(torch.as_tensor(a)))
    def _A_setup():
        B, S, D, H = 1, 2048, 640, 32
        Dh = D // H
        return {
            "x": _w((lambda *s: torch.randn(*s, dtype=torch.bfloat16) * 0.2)(B, S, D)),
            "wqkv": _w((lambda *s: torch.randn(*s, dtype=torch.bfloat16) * 1.6)(D, 3 * D)),
            "w_phi": _w((lambda *s: torch.randn(*s, dtype=torch.bfloat16) * 1.6)(H, Dh, Dh) * (Dh ** -0.5)),
            "wo": _w((lambda *s: torch.randn(*s, dtype=torch.bfloat16) * 0.8)(D, D)),
        }
    _A_in = _A_setup()

    def _B_setup():
        B, S, D = 1, 2048, 640
        ns = torch.arange(S)[:, None] * torch.arange(S)[None, :]
        nd = torch.arange(D)[:, None] * torch.arange(D)[None, :]
        Ws_re = torch.cos(-2.0 * torch.pi * ns / S).to(float)
        Ws_im = torch.sin(-2.0 * torch.pi * ns / S).to(float)
        Wd_re = torch.cos(-2.0 * torch.pi * nd / D).to(float)
        Wd_im = torch.sin(-2.0 * torch.pi * nd / D).to(float)
        return {
            "x": _w((lambda *s: torch.randn(*s, dtype=torch.bfloat16) * 0.05)(B, S, D)),
            "dft_seq_re": _w(Ws_re),
            "dft_seq_im": _w(Ws_im),
            "dft_hid_re": _w(Wd_re),
            "dft_hid_im": _w(Wd_im),
        }
    _B_in = _B_setup()

    return {
        "A_x": _A_in["x"],
        "A_wqkv": _A_in["wqkv"],
        "A_w_phi": _A_in["w_phi"],
        "A_wo": _A_in["wo"],
        "B_x": _B_in["x"],
        "B_dft_seq_re": _B_in["dft_seq_re"],
        "B_dft_seq_im": _B_in["dft_seq_im"],
        "B_dft_hid_re": _B_in["dft_hid_re"],
        "B_dft_hid_im": _B_in["dft_hid_im"],
    }

def reference(A_x, A_wqkv, A_w_phi, A_wo, B_x, B_dft_seq_re, B_dft_seq_im, B_dft_hid_re, B_dft_hid_im):
    def _A_ref(x, wqkv, w_phi, wo):
        B, S, D = x.shape
        H = 32; Dh = D // H
        qkv = (lambda x, *d: x.permute(*d))((x @ wqkv).reshape(B, S, 3, H, Dh), 2, 0, 3, 1, 4)
        q, k, v = qkv[0], qkv[1], qkv[2]
        pq = torch.einsum("bhsd,hdf->bhsf", q, w_phi)
        pk = torch.einsum("bhsd,hdf->bhsf", k, w_phi)
        phi_q = torch.concatenate([_softmax(pq, axis=-1), _softmax(-pq, axis=-1)], axis=-1)
        phi_k = torch.concatenate([_softmax(pk, axis=-1), _softmax(-pk, axis=-1)], axis=-1)
        kv = torch.einsum("bhsf,bhsd->bhfd", phi_k, v)
        z  = torch.einsum("bhsf->bhf", phi_k)
        num = torch.einsum("bhqf,bhfd->bhqd", phi_q, kv)
        den = torch.einsum("bhqf,bhf->bhq", phi_q, z)[..., None] + 1e-6
        o = num / den
        return (lambda x, *d: x.permute(*d))(o, 0, 2, 1, 3).reshape(B, S, D) @ wo

    def _B_ref(x, dft_seq_re, dft_seq_im, dft_hid_re, dft_hid_im):
        a = torch.einsum("bsd,ed->bse", x, dft_hid_re)
        b = torch.einsum("bsd,ed->bse", x, dft_hid_im)
        y = torch.einsum("ts,bse->bte", dft_seq_re, a) - torch.einsum("ts,bse->bte", dft_seq_im, b)
        return y

    a = _A_ref(A_x, A_wqkv, A_w_phi, A_wo)
    b = _B_ref(B_x, B_dft_seq_re, B_dft_seq_im, B_dft_hid_re, B_dft_hid_im)
    return torch.concatenate([a, b], axis=-1)
```

```asm
; @launch grid=(256,1,1) block=(512,1,1) lds=163840
.amdgcn_target "amdgcn-amd-amdhsa--gfx950"
.text
.globl concat_heads__linear_kernel_hedgehog__spectral_fnet__prompt_kernel
.p2align 8
.type concat_heads__linear_kernel_hedgehog__spectral_fnet__prompt_kernel,@function
concat_heads__linear_kernel_hedgehog__spectral_fnet__prompt_kernel:
L_TEXT0:
    s_cmp_ge_u32 s2, 256
    s_cbranch_scc1 L_END
    s_load_dwordx2 s[8:9], s[0:1], 0
    s_load_dwordx2 s[12:13], s[0:1], 8
    s_load_dwordx2 s[24:25], s[0:1], 32
    s_load_dwordx2 s[36:37], s[0:1], 88
    s_load_dwordx4 s[4:7], s[0:1], 16
    s_load_dwordx4 s[56:59], s[0:1], 72
    v_lshrrev_b32 v2, 6, v0
    v_and_b32 v1, 63, v0
    v_readfirstlane_b32 s40, v2
    s_and_b32 s44, s2, 7
    s_lshr_b32 s45, s2, 3
    s_and_b32 s43, s45, 15
    s_and_b32 s41, s43, 3
    s_lshr_b32 s42, s43, 2
    s_and_b32 s66, s44, 3
    s_lshl2_add_u32 s41, s66, s41
    s_lshr_b32 s66, s44, 2
    s_lshl2_add_u32 s42, s66, s42
    s_and_b32 s47, s40, 3
    s_lshr_b32 s62, s40, 2
    s_mov_b32 s10, 2621440
    s_mov_b32 s11, 0x20000
    s_mov_b32 s14, 2457600
    s_mov_b32 s15, 0x20000
    s_cmp_ge_u32 s45, 16
    s_cbranch_scc1 L_QB
    s_cmp_ge_u32 s40, 4
    s_cbranch_scc0 L_KV_CP
    v_lshrrev_b32 v2, 3, v1
    v_and_b32 v3, 7, v1
    v_lshrrev_b32 v13, 4, v1
    v_xor_b32 v3, v3, v13
    v_mul_u32_u24 v2, 1280, v2
    v_lshl_add_u32 v236, v3, 4, v2
    v_xor_b32 v3, 64, v236
    v_add_u32 v237, 9216, v3
    v_add_u32 v238, 18432, v236
    v_add_u32 v239, 27648, v3
    s_lshl2_add_u32 s50, s41, s47
    s_mul_i32 s50, s50, 40960
    s_lshl_b32 s49, s47, 12
    s_waitcnt lgkmcnt(0)
    s_add_u32 m0, s49, 0
    s_nop 0
    buffer_load_dwordx4 v236, s[8:11], s50 offen offset:0 lds
    buffer_load_dwordx4 v237, s[8:11], s50 offen offset:1024 lds
    buffer_load_dwordx4 v238, s[8:11], s50 offen offset:2048 lds
    buffer_load_dwordx4 v239, s[8:11], s50 offen offset:3072 lds
    s_mul_i32 s53, s47, 1024
    s_add_u32 s53, s53, 16384
    s_mul_i32 s51, s47, 61440
    s_mul_i32 s66, s42, 160
    s_add_u32 s51, s51, s66
    s_add_u32 s51, s51, 1280
    v_mov_b32 v14, 1120
    v_add_u32 v4, 0, v1
    v_add_u32 v5, 64, v1
    v_add_u32 v6, 128, v1
    v_add_u32 v7, 192, v1
    v_add_u32 v8, 256, v1
    v_mul_u32_u24 v240, 3277, v4
    v_mul_u32_u24 v241, 3277, v5
    v_mul_u32_u24 v242, 3277, v6
    v_mul_u32_u24 v243, 3277, v7
    v_mul_u32_u24 v244, 3277, v8
    v_lshrrev_b32 v240, 16, v240
    v_lshrrev_b32 v241, 16, v241
    v_lshrrev_b32 v242, 16, v242
    v_lshrrev_b32 v243, 16, v243
    v_lshrrev_b32 v244, 16, v244
    s_movk_i32 s66, -20
    v_mad_i32_i24 v4, v240, s66, v4
    v_mad_i32_i24 v5, v241, s66, v5
    v_mad_i32_i24 v6, v242, s66, v6
    v_mad_i32_i24 v7, v243, s66, v7
    v_mad_i32_i24 v8, v244, s66, v8
    v_bfe_u32 v9, v240, 3, 1
    v_bfe_u32 v10, v241, 3, 1
    v_bfe_u32 v11, v242, 3, 1
    v_bfe_u32 v12, v243, 3, 1
    v_bfe_u32 v13, v244, 3, 1
    v_lshlrev_b32 v9, 1, v9
    v_lshlrev_b32 v10, 1, v10
    v_lshlrev_b32 v11, 1, v11
    v_lshlrev_b32 v12, 1, v12
    v_lshlrev_b32 v13, 1, v13
    v_xor_b32 v4, v4, v9
    v_xor_b32 v5, v5, v10
    v_xor_b32 v6, v6, v11
    v_xor_b32 v7, v7, v12
    v_xor_b32 v8, v8, v13
    v_cmp_lt_u32 vcc, 9, v4
    v_mul_u32_u24 v240, 3840, v240
    v_lshl_add_u32 v240, v4, 4, v240
    v_cndmask_b32 v4, 0, v14, vcc
    v_add_u32 v240, v240, v4
    v_cmp_lt_u32 vcc, 9, v5
    v_mul_u32_u24 v241, 3840, v241
    v_lshl_add_u32 v241, v5, 4, v241
    v_cndmask_b32 v5, 0, v14, vcc
    v_subrev_u32 v241, 1024, v241
    v_add_u32 v241, v241, v5
    v_cmp_lt_u32 vcc, 9, v6
    v_mul_u32_u24 v242, 3840, v242
    v_lshl_add_u32 v242, v6, 4, v242
    v_cndmask_b32 v6, 0, v14, vcc
    v_subrev_u32 v242, 2048, v242
    v_add_u32 v242, v242, v6
    v_cmp_lt_u32 vcc, 9, v7
    v_mul_u32_u24 v243, 3840, v243
    v_lshl_add_u32 v243, v7, 4, v243
    v_cndmask_b32 v7, 0, v14, vcc
    v_subrev_u32 v243, 3072, v243
    v_add_u32 v243, v243, v7
    v_cmp_lt_u32 vcc, 9, v8
    v_mul_u32_u24 v244, 3840, v244
    v_lshl_add_u32 v244, v8, 4, v244
    v_cndmask_b32 v8, 0, v14, vcc
    v_add_u32 v244, v244, v8
    s_add_u32 m0, m0, s53
    s_nop 0
    buffer_load_dwordx4 v240, s[12:15], s51 offen offset:0 lds
    buffer_load_dwordx4 v241, s[12:15], s51 offen offset:1024 lds
    buffer_load_dwordx4 v242, s[12:15], s51 offen offset:2048 lds
    buffer_load_dwordx4 v243, s[12:15], s51 offen offset:3072 lds
    s_add_u32 m0, m0, 4096
    s_nop 0
    buffer_load_dwordx4 v244, s[12:15], s51 offen lds
    s_add_u32 m0, s49, 36864
    s_add_u32 s50, s50, 128
    buffer_load_dwordx4 v236, s[8:11], s50 offen offset:0 lds
    buffer_load_dwordx4 v237, s[8:11], s50 offen offset:1024 lds
    buffer_load_dwordx4 v238, s[8:11], s50 offen offset:2048 lds
    buffer_load_dwordx4 v239, s[8:11], s50 offen offset:3072 lds
    s_mov_b32 s26, 2621440
    s_mov_b32 s27, 0x20000
    s_mov_b32 s38, 16777216
    s_mov_b32 s39, 0x20000
    s_mov_b32 s18, 25600
    s_mov_b32 s19, 0x20000
    s_mov_b32 s22, 819200
    s_mov_b32 s23, 0x20000
    s_mov_b32 s30, 5242880
    s_mov_b32 s31, 0x20000
    s_mov_b32 s34, 256
    s_mov_b32 s35, 0x20000
    s_mov_b64 s[16:17], s[4:5]
    s_mov_b64 s[20:21], s[6:7]
    s_mov_b64 s[28:29], s[56:57]
    s_mov_b64 s[32:33], s[58:59]
    s_mul_i32 s66, s47, 3072
    s_add_u32 s66, s66, 36864
    v_lshl_add_u32 v188, v1, 4, s66
    v_bfe_u32 v10, v1, 4, 1
    v_bfe_u32 v11, v1, 2, 2
    v_and_b32 v12, 3, v1
    v_lshrrev_b32 v9, 5, v1
    v_lshl_add_u32 v13, v10, 2, v12
    v_lshl_add_u32 v14, v9, 3, v11
    v_mul_u32_u24 v14, 80, v14
    v_lshl_add_u32 v14, v13, 3, v14
    s_mul_i32 s66, s62, 3840
    s_add_u32 s66, s66, 156160
    v_add_u32 v189, s66, v14
    v_and_b32 v2, 31, v1
    s_lshl_b32 s66, s47, 5
    v_add_u32 v3, s66, v2
    v_mul_u32_u24 v196, 168, v3
    v_and_b32 v4, 15, v1
    v_add_u32 v4, s66, v4
    v_mul_u32_u24 v4, 168, v4
    v_lshrrev_b32 v5, 4, v1
    v_lshl_add_u32 v195, v5, 3, v4
    v_mul_u32_u24 v3, 336, v3
    v_mul_u32_u24 v14, 80, v9
    s_mul_i32 s66, s62, 160
    s_add_u32 s66, s66, 88064
    v_add3_u32 v190, v3, v14, s66
    s_mov_b32 s68, s47
    s_mov_b32 s69, s62
    v_lshl_add_u32 v11, v9, 3, v11
    s_mul_i32 s66, s68, 40
    v_lshl_add_u32 v14, v13, 3, s66
    v_mov_b32 v15, 160
    v_cmp_gt_u32 vcc, 5, v13
    v_mul_u32_u24 v4, 168, v11
    v_mul_u32_u24 v5, 336, v11
    v_cndmask_b32 v14, v15, v14, vcc
    v_add_u32 v191, v4, v14
    s_mul_i32 s66, s68, 80
    s_lshl_b32 s67, s69, 6
    s_add_u32 s66, s66, s67
    s_add_u32 s66, s66, 88064
    v_lshl_add_u32 v5, v13, 3, v5
    v_add_u32 v192, s66, v5
    v_lshlrev_b32 v6, 2, v2
    v_mul_u32_u24 v3, 384, v9
    v_add_u32 v6, v6, v3
    s_cmp_eq_u32 s69, 0
    s_cselect_b32 s66, 32, 8
    v_mov_b32 v15, 0x40000000
    v_cmp_gt_u32 vcc, s66, v2
    s_lshl2_add_u32 s52, s42, s68
    s_mul_i32 s52, s52, 2112
    s_and_b32 s66, s44, 1
    s_mul_i32 s66, s66, 67584
    s_add_u32 s52, s52, s66
    v_cndmask_b32 v193, v15, v6, vcc
    v_cmp_gt_u32 vcc, 32, v1
    s_lshl_b32 s66, s69, 7
    s_add_u32 s52, s52, s66
    v_cndmask_b32 v194, v15, v193, vcc
    v_add_u32 v4, 0, v1
    v_add_u32 v5, 64, v1
    v_add_u32 v6, 128, v1
    v_add_u32 v7, 192, v1
    v_add_u32 v8, 256, v1
    v_mul_u32_u24 v245, 6554, v4
    v_mul_u32_u24 v246, 6554, v5
    v_mul_u32_u24 v247, 6554, v6
    v_mul_u32_u24 v248, 6554, v7
    v_mul_u32_u24 v249, 6554, v8
    v_lshrrev_b32 v245, 16, v245
    v_lshrrev_b32 v246, 16, v246
    v_lshrrev_b32 v247, 16, v247
    v_lshrrev_b32 v248, 16, v248
    v_lshrrev_b32 v249, 16, v249
    v_mul_u32_u24 v245, 1120, v245
    v_mul_u32_u24 v246, 1120, v246
    v_mul_u32_u24 v247, 1120, v247
    v_mul_u32_u24 v248, 1120, v248
    v_mul_u32_u24 v249, 1120, v249
    v_lshl_add_u32 v245, v4, 4, v245
    v_lshl_add_u32 v246, v5, 4, v246
    v_lshl_add_u32 v247, v6, 4, v247
    v_lshl_add_u32 v248, v7, 4, v248
    v_lshl_add_u32 v249, v8, 4, v249
    v_subrev_u32 v246, 1024, v246
    v_subrev_u32 v247, 2048, v247
    v_subrev_u32 v248, 3072, v248
    v_and_b32 v2, 31, v1
    v_lshrrev_b32 v9, 5, v1
    v_lshlrev_b32 v3, 4, v1
    s_lshl_b32 s59, s40, 11
    s_add_u32 s59, s59, 36864
    v_and_b32 v5, 15, v1
    v_lshrrev_b32 v6, 4, v1
    v_lshlrev_b32 v4, 2, v5
    v_lshl_add_u32 v4, v6, 9, v4
    v_add_u32 v4, s59, v4
    v_add_u32 v198, 23552, v3
    v_add_u32 v208, 139392, v3
    v_mul_u32_u24 v5, 1288, v5
    v_lshl_add_u32 v5, v6, 3, v5
    s_lshl_b32 s59, s40, 6
    s_add_u32 s59, s59, 0
    v_add_u32 v5, s59, v5
    v_bfe_u32 v10, v1, 4, 1
    v_bfe_u32 v11, v1, 2, 2
    v_and_b32 v12, 3, v1
    v_lshrrev_b32 v9, 5, v1
    v_lshlrev_b32 v11, 6, v11
    v_lshl_add_u32 v11, v10, 5, v11
    v_lshl_add_u32 v11, v12, 3, v11
    s_mul_i32 s59, s40, 2576
    s_add_u32 s59, s59, 0
    v_add_u32 v11, s59, v11
    v_lshl_add_u32 v6, v9, 9, v11
    v_mul_u32_u24 v7, 520, v9
    v_add_u32 v7, v7, v11
    s_mul_i32 s59, s40, 3024
    s_add_u32 s59, s59, 139392
    v_mul_u32_u24 v8, 1440, v9
    v_lshl_add_u32 v8, v2, 2, v8
    v_add_u32 v8, s59, v8
    v_bfe_u32 v12, v1, 3, 2
    v_and_b32 v13, 3, v1
    v_lshl_add_u32 v12, v12, 2, v13
    v_min_u32 v12, 10, v12
    v_bfe_u32 v13, v1, 2, 1
    v_mul_u32_u24 v13, 10, v13
    v_add_u32 v12, v12, v13
    v_mul_u32_u24 v12, 144, v12
    v_lshl_add_u32 v12, v9, 4, v12
    v_add_u32 v12, s59, v12
    v_mul_u32_u24 v13, 40, v2
    v_mul_u32_u24 v14, 20, v9
    v_add_u32 v13, v13, v14
    v_sub_u32 v14, 2540, v13
    v_add_u32 v13, 1280, v13
    v_mov_b32 v199, v4
    v_mov_b32 v200, v5
    v_mov_b32 v201, v6
    v_mov_b32 v202, v7
    v_mov_b32 v203, v8
    v_mov_b32 v204, v11
    v_mov_b32 v205, v12
    v_mov_b32 v206, v13
    v_mov_b32 v207, v14
    v_lshrrev_b32 v2, 5, v1
    v_bfe_u32 v3, v1, 4, 1
    v_and_b32 v9, 15, v1
    v_lshlrev_b32 v4, 10, v2
    v_lshl_add_u32 v4, v3, 9, v4
    v_lshl_add_u32 v209, v9, 4, v4
    v_mul_u32_u24 v5, 5120, v2
    v_lshl_add_u32 v5, v3, 8, v5
    v_lshl_add_u32 v210, v9, 3, v5
    v_bfe_u32 v10, v1, 2, 2
    v_and_b32 v11, 3, v1
    v_mul_u32_u24 v12, 20, v3
    v_add_u32 v12, v12, v10
    v_lshl_add_u32 v6, v2, 3, v12
    v_mul_u32_u24 v6, 160, v6
    v_lshl_add_u32 v6, v11, 3, v6
    v_mul_u32_u24 v7, 80, v2
    v_add3_u32 v7, v7, v12, 16
    v_mul_u32_u24 v7, 160, v7
    v_lshl_add_u32 v7, v11, 3, v7
    s_mul_i32 s66, s62, 51200
    s_add_u32 s66, s66, 36864
    v_add_u32 v211, s66, v6
    v_add_u32 v212, s66, v7
    s_and_b32 s66, s45, 3
    s_lshl2_add_u32 s66, s44, s66
    s_lshr_b32 s3, s66, 1
    s_bfe_u32 s68, s45, 0x20002
    s_lshl2_add_u32 s3, s3, s68
    s_lshl_b32 s3, s3, 8
    s_add_u32 s3, s3, 147456
    s_lshr_b32 s68, s47, 1
    s_lshl1_add_u32 s67, s66, s68
    s_lshl1_add_u32 s67, s67, s62
    s_mul_i32 s67, s67, 20480
    s_add_u32 s67, s67, 524288
    s_and_b32 s68, s47, 1
    s_lshl_b32 s69, s68, 7
    s_add_u32 s69, s69, s67
    s_add_u32 s4, s69, 4096
    s_lshl_b32 s68, s68, 8
    s_add_u32 s5, s67, s68
    s_lshl2_add_u32 s66, s66, s47
    s_mul_i32 s66, s66, 40960
    s_lshr_b32 s68, s45, 2
    s_mul_i32 s68, s68, 160
    s_add_u32 s6, s66, s68
    v_mul_u32_u24 v8, 2560, v9
    v_lshrrev_b32 v2, 4, v1
    v_lshl_add_u32 v213, v2, 3, v8
    v_lshrrev_b32 v2, 5, v1
    v_lshl_add_u32 v8, v3, 5, v8
    v_lshl_add_u32 v215, v2, 4, v8
    s_mul_i32 s66, s47, 5120
    s_add_u32 s66, s66, 0
    v_lshl_add_u32 v214, v1, 4, s66
    s_add_u32 m0, m0, s53
    s_add_u32 s51, s51, 245760
    buffer_load_dwordx4 v240, s[12:15], s51 offen offset:0 lds
    buffer_load_dwordx4 v241, s[12:15], s51 offen offset:1024 lds
    buffer_load_dwordx4 v242, s[12:15], s51 offen offset:2048 lds
    buffer_load_dwordx4 v243, s[12:15], s51 offen offset:3072 lds
    s_add_u32 m0, m0, 4096
    s_nop 0
    buffer_load_dwordx4 v244, s[12:15], s51 offen lds
    s_waitcnt vmcnt(9)
    s_barrier
    s_add_u32 m0, s49, 73728
    s_add_u32 s50, s50, 128
    buffer_load_dwordx4 v236, s[8:11], s50 offen offset:0 lds
    buffer_load_dwordx4 v237, s[8:11], s50 offen offset:1024 lds
    buffer_load_dwordx4 v238, s[8:11], s50 offen offset:2048 lds
    buffer_load_dwordx4 v239, s[8:11], s50 offen offset:3072 lds
    s_add_u32 m0, m0, s53
    s_add_u32 s51, s51, 245760
    buffer_load_dwordx4 v240, s[12:15], s51 offen offset:0 lds
    buffer_load_dwordx4 v241, s[12:15], s51 offen offset:1024 lds
    buffer_load_dwordx4 v242, s[12:15], s51 offen offset:2048 lds
    buffer_load_dwordx4 v243, s[12:15], s51 offen offset:3072 lds
    s_add_u32 m0, m0, 4096
    s_nop 0
    buffer_load_dwordx4 v244, s[12:15], s51 offen lds
    s_waitcnt vmcnt(9)
    s_barrier
    s_add_u32 m0, s49, 0
    s_add_u32 s50, s50, 128
    buffer_load_dwordx4 v236, s[8:11], s50 offen offset:0 lds
    buffer_load_dwordx4 v237, s[8:11], s50 offen offset:1024 lds
    buffer_load_dwordx4 v238, s[8:11], s50 offen offset:2048 lds
    buffer_load_dwordx4 v239, s[8:11], s50 offen offset:3072 lds
    s_add_u32 m0, m0, s53
    s_add_u32 s51, s51, 245760
    buffer_load_dwordx4 v240, s[12:15], s51 offen offset:0 lds
    buffer_load_dwordx4 v241, s[12:15], s51 offen offset:1024 lds
    buffer_load_dwordx4 v242, s[12:15], s51 offen offset:2048 lds
    buffer_load_dwordx4 v243, s[12:15], s51 offen offset:3072 lds
    s_add_u32 m0, m0, 4096
    s_nop 0
    buffer_load_dwordx4 v244, s[12:15], s51 offen lds
    s_waitcnt vmcnt(9)
    s_barrier
    s_add_u32 m0, s49, 36864
    s_add_u32 s50, s50, 128
    buffer_load_dwordx4 v236, s[8:11], s50 offen offset:0 lds
    buffer_load_dwordx4 v237, s[8:11], s50 offen offset:1024 lds
    buffer_load_dwordx4 v238, s[8:11], s50 offen offset:2048 lds
    buffer_load_dwordx4 v239, s[8:11], s50 offen offset:3072 lds
    s_add_u32 m0, m0, s53
    s_add_u32 s51, s51, 245760
    buffer_load_dwordx4 v240, s[12:15], s51 offen offset:0 lds
    buffer_load_dwordx4 v241, s[12:15], s51 offen offset:1024 lds
    buffer_load_dwordx4 v242, s[12:15], s51 offen offset:2048 lds
    buffer_load_dwordx4 v243, s[12:15], s51 offen offset:3072 lds
    s_add_u32 m0, m0, 4096
    s_nop 0
    buffer_load_dwordx4 v244, s[12:15], s51 offen lds
    s_waitcnt vmcnt(9)
    s_barrier
    s_add_u32 m0, s49, 73728
    s_add_u32 s50, s50, 128
    buffer_load_dwordx4 v236, s[8:11], s50 offen offset:0 lds
    buffer_load_dwordx4 v237, s[8:11], s50 offen offset:1024 lds
    buffer_load_dwordx4 v238, s[8:11], s50 offen offset:2048 lds
    buffer_load_dwordx4 v239, s[8:11], s50 offen offset:3072 lds
    s_add_u32 m0, m0, s53
    s_add_u32 s51, s51, 245760
    buffer_load_dwordx4 v240, s[12:15], s51 offen offset:0 lds
    buffer_load_dwordx4 v241, s[12:15], s51 offen offset:1024 lds
    buffer_load_dwordx4 v242, s[12:15], s51 offen offset:2048 lds
    buffer_load_dwordx4 v243, s[12:15], s51 offen offset:3072 lds
    s_add_u32 m0, m0, 4096
    s_nop 0
    buffer_load_dwordx4 v244, s[12:15], s51 offen lds
    s_waitcnt vmcnt(9)
    s_barrier
    s_add_u32 m0, s49, 0
    s_add_u32 s50, s50, 128
    buffer_load_dwordx4 v236, s[8:11], s50 offen offset:0 lds
    buffer_load_dwordx4 v237, s[8:11], s50 offen offset:1024 lds
    buffer_load_dwordx4 v238, s[8:11], s50 offen offset:2048 lds
    buffer_load_dwordx4 v239, s[8:11], s50 offen offset:3072 lds
    s_add_u32 m0, m0, s53
    s_add_u32 s51, s51, 245760
    buffer_load_dwordx4 v240, s[12:15], s51 offen offset:0 lds
    buffer_load_dwordx4 v241, s[12:15], s51 offen offset:1024 lds
    buffer_load_dwordx4 v242, s[12:15], s51 offen offset:2048 lds
    buffer_load_dwordx4 v243, s[12:15], s51 offen offset:3072 lds
    s_add_u32 m0, m0, 4096
    s_nop 0
    buffer_load_dwordx4 v244, s[12:15], s51 offen lds
    s_waitcnt vmcnt(9)
    s_barrier
    s_add_u32 m0, s49, 36864
    s_add_u32 s50, s50, 128
    buffer_load_dwordx4 v236, s[8:11], s50 offen offset:0 lds
    buffer_load_dwordx4 v237, s[8:11], s50 offen offset:1024 lds
    buffer_load_dwordx4 v238, s[8:11], s50 offen offset:2048 lds
    buffer_load_dwordx4 v239, s[8:11], s50 offen offset:3072 lds
    s_add_u32 m0, m0, s53
    s_add_u32 s51, s51, 245760
    buffer_load_dwordx4 v240, s[12:15], s51 offen offset:0 lds
    buffer_load_dwordx4 v241, s[12:15], s51 offen offset:1024 lds
    buffer_load_dwordx4 v242, s[12:15], s51 offen offset:2048 lds
    buffer_load_dwordx4 v243, s[12:15], s51 offen offset:3072 lds
    s_add_u32 m0, m0, 4096
    s_nop 0
    buffer_load_dwordx4 v244, s[12:15], s51 offen lds
    s_waitcnt vmcnt(9)
    s_barrier
    s_add_u32 m0, s49, 73728
    s_add_u32 s50, s50, 128
    buffer_load_dwordx4 v236, s[8:11], s50 offen offset:0 lds
    buffer_load_dwordx4 v237, s[8:11], s50 offen offset:1024 lds
    buffer_load_dwordx4 v238, s[8:11], s50 offen offset:2048 lds
    buffer_load_dwordx4 v239, s[8:11], s50 offen offset:3072 lds
    s_add_u32 m0, m0, s53
    s_add_u32 s51, s51, 245760
    buffer_load_dwordx4 v240, s[12:15], s51 offen offset:0 lds
    buffer_load_dwordx4 v241, s[12:15], s51 offen offset:1024 lds
    buffer_load_dwordx4 v242, s[12:15], s51 offen offset:2048 lds
    buffer_load_dwordx4 v243, s[12:15], s51 offen offset:3072 lds
    s_add_u32 m0, m0, 4096
    s_nop 0
    buffer_load_dwordx4 v244, s[12:15], s51 offen lds
    s_waitcnt vmcnt(9)
    s_barrier
    s_add_u32 m0, s49, 0
    s_add_u32 s50, s50, 128
    buffer_load_dwordx4 v236, s[8:11], s50 offen offset:0 lds
    buffer_load_dwordx4 v237, s[8:11], s50 offen offset:1024 lds
    buffer_load_dwordx4 v238, s[8:11], s50 offen offset:2048 lds
    buffer_load_dwordx4 v239, s[8:11], s50 offen offset:3072 lds
    s_add_u32 m0, m0, s53
    s_add_u32 s51, s51, 245760
    buffer_load_dwordx4 v240, s[12:15], s51 offen offset:0 lds
    buffer_load_dwordx4 v241, s[12:15], s51 offen offset:1024 lds
    buffer_load_dwordx4 v242, s[12:15], s51 offen offset:2048 lds
    buffer_load_dwordx4 v243, s[12:15], s51 offen offset:3072 lds
    s_add_u32 m0, m0, 4096
    s_nop 0
    buffer_load_dwordx4 v244, s[12:15], s51 offen lds
    s_waitcnt vmcnt(9)
    s_barrier
    s_waitcnt vmcnt(0) lgkmcnt(0)
    s_barrier
    s_lshl2_add_u32 s66, s41, s47
    s_lshl3_add_u32 s66, s66, s42
    s_mul_i32 s66, s66, 5120
    s_add_u32 s66, s66, 524288
    s_add_u32 s67, s66, 4096
    v_lshlrev_b32 v2, 4, v1
    v_mov_b32 v4, -1
    v_mov_b32 v5, -1
    v_mov_b32 v6, -1
    v_mov_b32 v7, -1
    buffer_store_dwordx4 v[4:7], v2, s[36:39], s66 offen offset:0 sc1
    buffer_store_dwordx4 v[4:7], v2, s[36:39], s66 offen offset:1024 sc1
    buffer_store_dwordx4 v[4:7], v2, s[36:39], s66 offen offset:2048 sc1
    buffer_store_dwordx4 v[4:7], v2, s[36:39], s66 offen offset:3072 sc1
    buffer_store_dwordx4 v[4:7], v2, s[36:39], s67 offen sc1
    s_lshl2_add_u32 s66, s43, s47
    s_mul_i32 s67, s66, 205
    s_lshr_b32 s67, s67, 10
    s_mul_i32 s68, s67, 81280
    s_lshl_b32 s66, s66, 7
    s_add_u32 s66, s66, s68
    v_mul_u32_u24 v250, 1280, v1
    buffer_load_dword v251, v250, s[20:23], s66 offen offset:640
    ds_read_b64_tr_b16 v[164:165], v189 offset:0
    ds_read_b64_tr_b16 v[166:167], v189 offset:320
    ds_read_b64_tr_b16 v[168:169], v189 offset:1280
    ds_read_b64_tr_b16 v[170:171], v189 offset:1600
    ds_read_b64_tr_b16 v[172:173], v189 offset:2560
    ds_read_b64_tr_b16 v[174:175], v189 offset:2880
    ds_read_b64_tr_b16 v[176:177], v189 offset:64
    ds_read_b64_tr_b16 v[178:179], v189 offset:384
    ds_read_b64_tr_b16 v[180:181], v189 offset:1344
    ds_read_b64_tr_b16 v[182:183], v189 offset:1664
    ds_read_b64_tr_b16 v[184:185], v189 offset:2624
    ds_read_b64_tr_b16 v[186:187], v189 offset:2944
    s_waitcnt lgkmcnt(0)
    s_branch L_PHIK
L_KV_CP:
    v_and_b32 v2, 15, v1
    v_bfe_u32 v3, v1, 1, 3
    v_lshrrev_b32 v9, 4, v1
    v_xor_b32 v3, v3, v9
    s_lshl_b32 s66, s47, 12
    v_lshlrev_b32 v2, 7, v2
    v_lshl_add_u32 v2, v3, 4, v2
    v_add_u32 v144, s66, v2
    v_xor_b32 v145, 64, v144
    v_add_u32 v146, 36864, v144
    v_add_u32 v147, 36864, v145
    v_add_u32 v148, 73728, v144
    v_add_u32 v149, 73728, v145
    v_bfe_u32 v11, v1, 2, 2
    v_and_b32 v12, 3, v1
    v_lshl_add_u32 v11, v9, 3, v11
    v_mul_u32_u24 v11, 320, v11
    v_lshl_add_u32 v11, v12, 3, v11
    v_and_b32 v10, 1, v9
    v_lshlrev_b32 v10, 5, v10
    v_add_u32 v12, v11, v10
    v_sub_u32 v11, v11, v10
    v_add_u32 v150, 16384, v12
    v_add_u32 v151, 16384, v11
    v_add_u32 v152, 53248, v12
    v_add_u32 v153, 53248, v11
    v_add_u32 v154, 90112, v12
    v_add_u32 v155, 90112, v11
    s_waitcnt lgkmcnt(0)
    s_mov_b32 s26, 2621440
    s_mov_b32 s27, 0x20000
    s_mov_b32 s38, 16777216
    s_mov_b32 s39, 0x20000
    s_mov_b32 s18, 25600
    s_mov_b32 s19, 0x20000
    s_mov_b32 s22, 819200
    s_mov_b32 s23, 0x20000
    s_mov_b32 s30, 5242880
    s_mov_b32 s31, 0x20000
    s_mov_b32 s34, 256
    s_mov_b32 s35, 0x20000
    s_mov_b64 s[16:17], s[4:5]
    s_mov_b64 s[20:21], s[6:7]
    s_mov_b64 s[28:29], s[56:57]
    s_mov_b64 s[32:33], s[58:59]
    s_lshl2_add_u32 s66, s42, s47
    s_mul_i32 s66, s66, 800
    v_lshlrev_b32 v2, 3, v1
    v_add_u32 v3, 512, v2
    v_cmp_gt_u32 vcc, 36, v1
    v_mov_b32 v9, 0x40000000
    buffer_load_dwordx2 v[224:225], v2, s[16:19], s66 offen
    v_cndmask_b32 v3, v9, v3, vcc
    buffer_load_dwordx2 v[228:229], v3, s[16:19], s66 offen
    s_mul_i32 s66, s47, 3072
    s_add_u32 s66, s66, 36864
    v_lshl_add_u32 v188, v1, 4, s66
    v_bfe_u32 v10, v1, 4, 1
    v_bfe_u32 v11, v1, 2, 2
    v_and_b32 v12, 3, v1
    v_lshrrev_b32 v9, 5, v1
    v_lshl_add_u32 v13, v10, 2, v12
    v_lshl_add_u32 v14, v9, 3, v11
    v_mul_u32_u24 v14, 80, v14
    v_lshl_add_u32 v14, v13, 3, v14
    s_mul_i32 s66, s62, 3840
    s_add_u32 s66, s66, 156160
    v_add_u32 v189, s66, v14
    v_and_b32 v2, 31, v1
    s_lshl_b32 s66, s47, 5
    v_add_u32 v3, s66, v2
    v_mul_u32_u24 v196, 168, v3
    v_and_b32 v4, 15, v1
    v_add_u32 v4, s66, v4
    v_mul_u32_u24 v4, 168, v4
    v_lshrrev_b32 v5, 4, v1
    v_lshl_add_u32 v195, v5, 3, v4
    v_mul_u32_u24 v3, 336, v3
    v_mul_u32_u24 v14, 80, v9
    s_mul_i32 s66, s62, 160
    s_add_u32 s66, s66, 88064
    v_add3_u32 v190, v3, v14, s66
    s_mov_b32 s68, s47
    s_mov_b32 s69, s62
    v_lshl_add_u32 v11, v9, 3, v11
    s_mul_i32 s66, s68, 40
    v_lshl_add_u32 v14, v13, 3, s66
    v_mov_b32 v15, 160
    v_cmp_gt_u32 vcc, 5, v13
    v_mul_u32_u24 v4, 168, v11
    v_mul_u32_u24 v5, 336, v11
    v_cndmask_b32 v14, v15, v14, vcc
    v_add_u32 v191, v4, v14
    s_mul_i32 s66, s68, 80
    s_lshl_b32 s67, s69, 6
    s_add_u32 s66, s66, s67
    s_add_u32 s66, s66, 88064
    v_lshl_add_u32 v5, v13, 3, v5
    v_add_u32 v192, s66, v5
    v_lshlrev_b32 v6, 2, v2
    v_mul_u32_u24 v3, 384, v9
    v_add_u32 v6, v6, v3
    s_cmp_eq_u32 s69, 0
    s_cselect_b32 s66, 32, 8
    v_mov_b32 v15, 0x40000000
    v_cmp_gt_u32 vcc, s66, v2
    s_lshl2_add_u32 s52, s42, s68
    s_mul_i32 s52, s52, 2112
    s_and_b32 s66, s44, 1
    s_mul_i32 s66, s66, 67584
    s_add_u32 s52, s52, s66
    v_cndmask_b32 v193, v15, v6, vcc
    v_cmp_gt_u32 vcc, 32, v1
    s_lshl_b32 s66, s69, 7
    s_add_u32 s52, s52, s66
    v_cndmask_b32 v194, v15, v193, vcc
    v_add_u32 v4, 0, v1
    v_add_u32 v5, 64, v1
    v_add_u32 v6, 128, v1
    v_add_u32 v7, 192, v1
    v_add_u32 v8, 256, v1
    v_mul_u32_u24 v245, 6554, v4
    v_mul_u32_u24 v246, 6554, v5
    v_mul_u32_u24 v247, 6554, v6
    v_mul_u32_u24 v248, 6554, v7
    v_mul_u32_u24 v249, 6554, v8
    v_lshrrev_b32 v245, 16, v245
    v_lshrrev_b32 v246, 16, v246
    v_lshrrev_b32 v247, 16, v247
    v_lshrrev_b32 v248, 16, v248
    v_lshrrev_b32 v249, 16, v249
    v_mul_u32_u24 v245, 1120, v245
    v_mul_u32_u24 v246, 1120, v246
    v_mul_u32_u24 v247, 1120, v247
    v_mul_u32_u24 v248, 1120, v248
    v_mul_u32_u24 v249, 1120, v249
    v_lshl_add_u32 v245, v4, 4, v245
    v_lshl_add_u32 v246, v5, 4, v246
    v_lshl_add_u32 v247, v6, 4, v247
    v_lshl_add_u32 v248, v7, 4, v248
    v_lshl_add_u32 v249, v8, 4, v249
    v_subrev_u32 v246, 1024, v246
    v_subrev_u32 v247, 2048, v247
    v_subrev_u32 v248, 3072, v248
    v_and_b32 v2, 31, v1
    v_lshrrev_b32 v9, 5, v1
    v_lshlrev_b32 v3, 4, v1
    s_lshl_b32 s59, s40, 11
    s_add_u32 s59, s59, 36864
    v_and_b32 v5, 15, v1
    v_lshrrev_b32 v6, 4, v1
    v_lshlrev_b32 v4, 2, v5
    v_lshl_add_u32 v4, v6, 9, v4
    v_add_u32 v4, s59, v4
    v_add_u32 v198, 23552, v3
    v_add_u32 v208, 139392, v3
    v_mul_u32_u24 v5, 1288, v5
    v_lshl_add_u32 v5, v6, 3, v5
    s_lshl_b32 s59, s40, 6
    s_add_u32 s59, s59, 0
    v_add_u32 v5, s59, v5
    v_bfe_u32 v10, v1, 4, 1
    v_bfe_u32 v11, v1, 2, 2
    v_and_b32 v12, 3, v1
    v_lshrrev_b32 v9, 5, v1
    v_lshlrev_b32 v11, 6, v11
    v_lshl_add_u32 v11, v10, 5, v11
    v_lshl_add_u32 v11, v12, 3, v11
    s_mul_i32 s59, s40, 2576
    s_add_u32 s59, s59, 0
    v_add_u32 v11, s59, v11
    v_lshl_add_u32 v6, v9, 9, v11
    v_mul_u32_u24 v7, 520, v9
    v_add_u32 v7, v7, v11
    s_mul_i32 s59, s40, 3024
    s_add_u32 s59, s59, 139392
    v_mul_u32_u24 v8, 1440, v9
    v_lshl_add_u32 v8, v2, 2, v8
    v_add_u32 v8, s59, v8
    v_bfe_u32 v12, v1, 3, 2
    v_and_b32 v13, 3, v1
    v_lshl_add_u32 v12, v12, 2, v13
    v_min_u32 v12, 10, v12
    v_bfe_u32 v13, v1, 2, 1
    v_mul_u32_u24 v13, 10, v13
    v_add_u32 v12, v12, v13
    v_mul_u32_u24 v12, 144, v12
    v_lshl_add_u32 v12, v9, 4, v12
    v_add_u32 v12, s59, v12
    v_mul_u32_u24 v13, 40, v2
    v_mul_u32_u24 v14, 20, v9
    v_add_u32 v13, v13, v14
    v_sub_u32 v14, 2540, v13
    v_add_u32 v13, 1280, v13
    v_mov_b32 v199, v4
    v_mov_b32 v200, v5
    v_mov_b32 v201, v6
    v_mov_b32 v202, v7
    v_mov_b32 v203, v8
    v_mov_b32 v204, v11
    v_mov_b32 v205, v12
    v_mov_b32 v206, v13
    v_mov_b32 v207, v14
    v_mov_b32 v209, 0
    v_mov_b32 v210, 0
    v_mov_b32 v213, 0
    v_mov_b32 v215, 0
    s_mul_i32 s66, s47, 1600
    s_lshr_b32 s67, s47, 1
    s_mul_i32 s67, s67, 1280
    s_add_u32 s66, s66, s67
    s_add_u32 s66, s66, 156160
    v_lshl_add_u32 v2, v1, 4, s66
    s_and_b32 s67, s47, 1
    s_cmp_eq_u32 s67, 0
    s_cselect_b32 s67, -1, 0
    s_not_b32 s68, s67
    s_waitcnt vmcnt(0)
    v_and_b32 v226, s68, v224
    v_and_b32 v227, s68, v225
    v_and_b32 v224, s67, v224
    v_and_b32 v225, s67, v225
    v_and_b32 v230, s68, v228
    v_and_b32 v231, s68, v229
    v_and_b32 v228, s67, v228
    v_and_b32 v229, s67, v229
    ds_write_b128 v2, v[224:227]
    v_cmp_gt_u32 vcc, 36, v1
    s_and_saveexec_b64 s[64:65], vcc
    ds_write_b128 v2, v[228:231] offset:1024
    s_mov_b64 exec, 0xfffff
    s_mul_i32 s66, s47, 320
    s_add_u32 s66, s66, 159360
    v_lshl_add_u32 v2, v1, 4, s66
    v_mov_b32 v232, 0
    v_mov_b32 v233, 0
    v_mov_b32 v234, 0
    v_mov_b32 v235, 0
    ds_write_b128 v2, v[232:235]
    s_mov_b64 exec, s[64:65]
    s_waitcnt lgkmcnt(0)
    s_barrier
    ds_read_b128 v[96:99], v144 offset:0
    ds_read_b128 v[100:103], v144 offset:2048
    ds_read_b64_tr_b16 v[112:113], v150 offset:0
    ds_read_b64_tr_b16 v[114:115], v150 offset:1280
    ds_read_b64_tr_b16 v[116:117], v151 offset:32
    ds_read_b64_tr_b16 v[118:119], v151 offset:1312
    ds_read_b64_tr_b16 v[120:121], v150 offset:64
    ds_read_b64_tr_b16 v[122:123], v150 offset:1344
    ds_read_b64_tr_b16 v[124:125], v151 offset:96
    ds_read_b64_tr_b16 v[126:127], v151 offset:1376
    ds_read_b64_tr_b16 v[128:129], v150 offset:128
    ds_read_b64_tr_b16 v[130:131], v150 offset:1408
    s_waitcnt lgkmcnt(6)
    v_mfma_f32_16x16x32_bf16 v[16:19], v[112:115], v[96:99], 0
    ds_read_b64_tr_b16 v[132:133], v151 offset:160
    ds_read_b64_tr_b16 v[134:135], v151 offset:1440
    v_mfma_f32_16x16x32_bf16 v[20:23], v[112:115], v[100:103], 0
    ds_read_b64_tr_b16 v[136:137], v150 offset:192
    ds_read_b64_tr_b16 v[138:139], v150 offset:1472
    v_mfma_f32_16x16x32_bf16 v[24:27], v[116:119], v[96:99], 0
    ds_read_b64_tr_b16 v[140:141], v151 offset:224
    v_mfma_f32_16x16x32_bf16 v[28:31], v[116:119], v[100:103], 0
    ds_read_b64_tr_b16 v[142:143], v151 offset:1504
    s_waitcnt lgkmcnt(8)
    v_mfma_f32_16x16x32_bf16 v[32:35], v[120:123], v[96:99], 0
    ds_read_b64_tr_b16 v[112:113], v150 offset:256
    v_mfma_f32_16x16x32_bf16 v[36:39], v[120:123], v[100:103], 0
    ds_read_b64_tr_b16 v[114:115], v150 offset:1536
    v_mfma_f32_16x16x32_bf16 v[40:43], v[124:127], v[96:99], 0
    ds_read_b64_tr_b16 v[116:117], v151 offset:288
    v_mfma_f32_16x16x32_bf16 v[44:47], v[124:127], v[100:103], 0
    ds_read_b64_tr_b16 v[118:119], v151 offset:1568
    s_waitcnt lgkmcnt(8)
    v_mfma_f32_16x16x32_bf16 v[48:51], v[128:131], v[96:99], 0
    ds_read_b128 v[104:107], v145 offset:0
    ds_read_b128 v[108:111], v145 offset:2048
    v_mfma_f32_16x16x32_bf16 v[52:55], v[128:131], v[100:103], 0
    ds_read_b64_tr_b16 v[120:121], v150 offset:10240
    ds_read_b64_tr_b16 v[122:123], v150 offset:11520
    v_mfma_f32_16x16x32_bf16 v[56:59], v[132:135], v[96:99], 0
    ds_read_b64_tr_b16 v[124:125], v151 offset:10272
    v_mfma_f32_16x16x32_bf16 v[60:63], v[132:135], v[100:103], 0
    ds_read_b64_tr_b16 v[126:127], v151 offset:11552
    s_waitcnt lgkmcnt(10)
    v_mfma_f32_16x16x32_bf16 v[64:67], v[136:139], v[96:99], 0
    ds_read_b64_tr_b16 v[128:129], v150 offset:10304
    v_mfma_f32_16x16x32_bf16 v[68:71], v[136:139], v[100:103], 0
    ds_read_b64_tr_b16 v[130:131], v150 offset:11584
    v_mfma_f32_16x16x32_bf16 v[72:75], v[140:143], v[96:99], 0
    ds_read_b64_tr_b16 v[132:133], v151 offset:10336
    v_mfma_f32_16x16x32_bf16 v[76:79], v[140:143], v[100:103], 0
    ds_read_b64_tr_b16 v[134:135], v151 offset:11616
    s_waitcnt lgkmcnt(10)
    v_mfma_f32_16x16x32_bf16 v[80:83], v[112:115], v[96:99], 0
    ds_read_b64_tr_b16 v[136:137], v150 offset:10368
    v_mfma_f32_16x16x32_bf16 v[84:87], v[112:115], v[100:103], 0
    ds_read_b64_tr_b16 v[138:139], v150 offset:11648
    v_mfma_f32_16x16x32_bf16 v[88:91], v[116:119], v[96:99], 0
    ds_read_b64_tr_b16 v[140:141], v151 offset:10400
    v_mfma_f32_16x16x32_bf16 v[92:95], v[116:119], v[100:103], 0
    ds_read_b64_tr_b16 v[142:143], v151 offset:11680
    s_waitcnt lgkmcnt(8)
    v_mfma_f32_16x16x32_bf16 v[16:19], v[120:123], v[104:107], v[16:19]
    ds_read_b64_tr_b16 v[112:113], v150 offset:10432
    v_mfma_f32_16x16x32_bf16 v[20:23], v[120:123], v[108:111], v[20:23]
    ds_read_b64_tr_b16 v[114:115], v150 offset:11712
    v_mfma_f32_16x16x32_bf16 v[24:27], v[124:127], v[104:107], v[24:27]
    ds_read_b64_tr_b16 v[116:117], v151 offset:10464
    v_mfma_f32_16x16x32_bf16 v[28:31], v[124:127], v[108:111], v[28:31]
    ds_read_b64_tr_b16 v[118:119], v151 offset:11744
    s_waitcnt lgkmcnt(8)
    v_mfma_f32_16x16x32_bf16 v[32:35], v[128:131], v[104:107], v[32:35]
    ds_read_b64_tr_b16 v[120:121], v150 offset:10496
    v_mfma_f32_16x16x32_bf16 v[36:39], v[128:131], v[108:111], v[36:39]
    ds_read_b64_tr_b16 v[122:123], v150 offset:11776
    v_mfma_f32_16x16x32_bf16 v[40:43], v[132:135], v[104:107], v[40:43]
    ds_read_b64_tr_b16 v[124:125], v151 offset:10528
    v_mfma_f32_16x16x32_bf16 v[44:47], v[132:135], v[108:111], v[44:47]
    ds_read_b64_tr_b16 v[126:127], v151 offset:11808
    s_waitcnt lgkmcnt(8)
    v_mfma_f32_16x16x32_bf16 v[48:51], v[136:139], v[104:107], v[48:51]
    v_mfma_f32_16x16x32_bf16 v[52:55], v[136:139], v[108:111], v[52:55]
    v_mfma_f32_16x16x32_bf16 v[56:59], v[140:143], v[104:107], v[56:59]
    v_mfma_f32_16x16x32_bf16 v[60:63], v[140:143], v[108:111], v[60:63]
    s_waitcnt lgkmcnt(4)
    v_mfma_f32_16x16x32_bf16 v[64:67], v[112:115], v[104:107], v[64:67]
    v_mfma_f32_16x16x32_bf16 v[68:71], v[112:115], v[108:111], v[68:71]
    s_waitcnt lgkmcnt(0)
    s_barrier
    v_mfma_f32_16x16x32_bf16 v[72:75], v[116:119], v[104:107], v[72:75]
    ds_read_b128 v[96:99], v146 offset:0
    ds_read_b128 v[100:103], v146 offset:2048
    v_mfma_f32_16x16x32_bf16 v[76:79], v[116:119], v[108:111], v[76:79]
    ds_read_b64_tr_b16 v[128:129], v152 offset:0
    ds_read_b64_tr_b16 v[130:131], v152 offset:1280
    v_mfma_f32_16x16x32_bf16 v[80:83], v[120:123], v[104:107], v[80:83]
    ds_read_b64_tr_b16 v[132:133], v153 offset:32
    ds_read_b64_tr_b16 v[134:135], v153 offset:1312
    v_mfma_f32_16x16x32_bf16 v[84:87], v[120:123], v[108:111], v[84:87]
    ds_read_b64_tr_b16 v[136:137], v152 offset:64
    ds_read_b64_tr_b16 v[138:139], v152 offset:1344
    v_mfma_f32_16x16x32_bf16 v[88:91], v[124:127], v[104:107], v[88:91]
    ds_read_b64_tr_b16 v[140:141], v153 offset:96
    ds_read_b64_tr_b16 v[142:143], v153 offset:1376
    v_mfma_f32_16x16x32_bf16 v[92:95], v[124:127], v[108:111], v[92:95]
    ds_read_b64_tr_b16 v[112:113], v152 offset:128
    ds_read_b64_tr_b16 v[114:115], v152 offset:1408
    s_waitcnt lgkmcnt(6)
    v_mfma_f32_16x16x32_bf16 v[16:19], v[128:131], v[96:99], v[16:19]
    ds_read_b64_tr_b16 v[116:117], v153 offset:160
    ds_read_b64_tr_b16 v[118:119], v153 offset:1440
    v_mfma_f32_16x16x32_bf16 v[20:23], v[128:131], v[100:103], v[20:23]
    ds_read_b64_tr_b16 v[120:121], v152 offset:192
    ds_read_b64_tr_b16 v[122:123], v152 offset:1472
    v_mfma_f32_16x16x32_bf16 v[24:27], v[132:135], v[96:99], v[24:27]
    ds_read_b64_tr_b16 v[124:125], v153 offset:224
    v_mfma_f32_16x16x32_bf16 v[28:31], v[132:135], v[100:103], v[28:31]
    ds_read_b64_tr_b16 v[126:127], v153 offset:1504
    s_waitcnt lgkmcnt(8)
    v_mfma_f32_16x16x32_bf16 v[32:35], v[136:139], v[96:99], v[32:35]
    ds_read_b64_tr_b16 v[128:129], v152 offset:256
    v_mfma_f32_16x16x32_bf16 v[36:39], v[136:139], v[100:103], v[36:39]
    ds_read_b64_tr_b16 v[130:131], v152 offset:1536
    v_mfma_f32_16x16x32_bf16 v[40:43], v[140:143], v[96:99], v[40:43]
    ds_read_b64_tr_b16 v[132:133], v153 offset:288
    v_mfma_f32_16x16x32_bf16 v[44:47], v[140:143], v[100:103], v[44:47]
    ds_read_b64_tr_b16 v[134:135], v153 offset:1568
    s_waitcnt lgkmcnt(8)
    v_mfma_f32_16x16x32_bf16 v[48:51], v[112:115], v[96:99], v[48:51]
    ds_read_b128 v[104:107], v147 offset:0
    ds_read_b128 v[108:111], v147 offset:2048
    v_mfma_f32_16x16x32_bf16 v[52:55], v[112:115], v[100:103], v[52:55]
    ds_read_b64_tr_b16 v[136:137], v152 offset:10240
    ds_read_b64_tr_b16 v[138:139], v152 offset:11520
    v_mfma_f32_16x16x32_bf16 v[56:59], v[116:119], v[96:99], v[56:59]
    ds_read_b64_tr_b16 v[140:141], v153 offset:10272
    v_mfma_f32_16x16x32_bf16 v[60:63], v[116:119], v[100:103], v[60:63]
    ds_read_b64_tr_b16 v[142:143], v153 offset:11552
    s_waitcnt lgkmcnt(10)
    v_mfma_f32_16x16x32_bf16 v[64:67], v[120:123], v[96:99], v[64:67]
    ds_read_b64_tr_b16 v[112:113], v152 offset:10304
    v_mfma_f32_16x16x32_bf16 v[68:71], v[120:123], v[100:103], v[68:71]
    ds_read_b64_tr_b16 v[114:115], v152 offset:11584
    v_mfma_f32_16x16x32_bf16 v[72:75], v[124:127], v[96:99], v[72:75]
    ds_read_b64_tr_b16 v[116:117], v153 offset:10336
    v_mfma_f32_16x16x32_bf16 v[76:79], v[124:127], v[100:103], v[76:79]
    ds_read_b64_tr_b16 v[118:119], v153 offset:11616
    s_waitcnt lgkmcnt(10)
    v_mfma_f32_16x16x32_bf16 v[80:83], v[128:131], v[96:99], v[80:83]
    ds_read_b64_tr_b16 v[120:121], v152 offset:10368
    v_mfma_f32_16x16x32_bf16 v[84:87], v[128:131], v[100:103], v[84:87]
    ds_read_b64_tr_b16 v[122:123], v152 offset:11648
    v_mfma_f32_16x16x32_bf16 v[88:91], v[132:135], v[96:99], v[88:91]
    ds_read_b64_tr_b16 v[124:125], v153 offset:10400
    v_mfma_f32_16x16x32_bf16 v[92:95], v[132:135], v[100:103], v[92:95]
    ds_read_b64_tr_b16 v[126:127], v153 offset:11680
    s_waitcnt lgkmcnt(8)
    v_mfma_f32_16x16x32_bf16 v[16:19], v[136:139], v[104:107], v[16:19]
    ds_read_b64_tr_b16 v[128:129], v152 offset:10432
    v_mfma_f32_16x16x32_bf16 v[20:23], v[136:139], v[108:111], v[20:23]
    ds_read_b64_tr_b16 v[130:131], v152 offset:11712
    v_mfma_f32_16x16x32_bf16 v[24:27], v[140:143], v[104:107], v[24:27]
    ds_read_b64_tr_b16 v[132:133], v153 offset:10464
    v_mfma_f32_16x16x32_bf16 v[28:31], v[140:143], v[108:111], v[28:31]
    ds_read_b64_tr_b16 v[134:135], v153 offset:11744
    s_waitcnt lgkmcnt(8)
    v_mfma_f32_16x16x32_bf16 v[32:35], v[112:115], v[104:107], v[32:35]
    ds_read_b64_tr_b16 v[136:137], v152 offset:10496
    v_mfma_f32_16x16x32_bf16 v[36:39], v[112:115], v[108:111], v[36:39]
    ds_read_b64_tr_b16 v[138:139], v152 offset:11776
    v_mfma_f32_16x16x32_bf16 v[40:43], v[116:119], v[104:107], v[40:43]
    ds_read_b64_tr_b16 v[140:141], v153 offset:10528
    v_mfma_f32_16x16x32_bf16 v[44:47], v[116:119], v[108:111], v[44:47]
    ds_read_b64_tr_b16 v[142:143], v153 offset:11808
    s_waitcnt lgkmcnt(8)
    v_mfma_f32_16x16x32_bf16 v[48:51], v[120:123], v[104:107], v[48:51]
    v_mfma_f32_16x16x32_bf16 v[52:55], v[120:123], v[108:111], v[52:55]
    v_mfma_f32_16x16x32_bf16 v[56:59], v[124:127], v[104:107], v[56:59]
    v_mfma_f32_16x16x32_bf16 v[60:63], v[124:127], v[108:111], v[60:63]
    s_waitcnt lgkmcnt(4)
    v_mfma_f32_16x16x32_bf16 v[64:67], v[128:131], v[104:107], v[64:67]
    v_mfma_f32_16x16x32_bf16 v[68:71], v[128:131], v[108:111], v[68:71]
    s_waitcnt lgkmcnt(0)
    s_barrier
    v_mfma_f32_16x16x32_bf16 v[72:75], v[132:135], v[104:107], v[72:75]
    ds_read_b128 v[96:99], v148 offset:0
    ds_read_b128 v[100:103], v148 offset:2048
    v_mfma_f32_16x16x32_bf16 v[76:79], v[132:135], v[108:111], v[76:79]
    ds_read_b64_tr_b16 v[112:113], v154 offset:0
    ds_read_b64_tr_b16 v[114:115], v154 offset:1280
    v_mfma_f32_16x16x32_bf16 v[80:83], v[136:139], v[104:107], v[80:83]
    ds_read_b64_tr_b16 v[116:117], v155 offset:32
    ds_read_b64_tr_b16 v[118:119], v155 offset:1312
    v_mfma_f32_16x16x32_bf16 v[84:87], v[136:139], v[108:111], v[84:87]
    ds_read_b64_tr_b16 v[120:121], v154 offset:64
    ds_read_b64_tr_b16 v[122:123], v154 offset:1344
    v_mfma_f32_16x16x32_bf16 v[88:91], v[140:143], v[104:107], v[88:91]
    ds_read_b64_tr_b16 v[124:125], v155 offset:96
    ds_read_b64_tr_b16 v[126:127], v155 offset:1376
    v_mfma_f32_16x16x32_bf16 v[92:95], v[140:143], v[108:111], v[92:95]
    ds_read_b64_tr_b16 v[128:129], v154 offset:128
    ds_read_b64_tr_b16 v[130:131], v154 offset:1408
    s_waitcnt lgkmcnt(6)
    v_mfma_f32_16x16x32_bf16 v[16:19], v[112:115], v[96:99], v[16:19]
    ds_read_b64_tr_b16 v[132:133], v155 offset:160
    ds_read_b64_tr_b16 v[134:135], v155 offset:1440
    v_mfma_f32_16x16x32_bf16 v[20:23], v[112:115], v[100:103], v[20:23]
    ds_read_b64_tr_b16 v[136:137], v154 offset:192
    ds_read_b64_tr_b16 v[138:139], v154 offset:1472
    v_mfma_f32_16x16x32_bf16 v[24:27], v[116:119], v[96:99], v[24:27]
    ds_read_b64_tr_b16 v[140:141], v155 offset:224
    v_mfma_f32_16x16x32_bf16 v[28:31], v[116:119], v[100:103], v[28:31]
    ds_read_b64_tr_b16 v[142:143], v155 offset:1504
    s_waitcnt lgkmcnt(8)
    v_mfma_f32_16x16x32_bf16 v[32:35], v[120:123], v[96:99], v[32:35]
    ds_read_b64_tr_b16 v[112:113], v154 offset:256
    v_mfma_f32_16x16x32_bf16 v[36:39], v[120:123], v[100:103], v[36:39]
    ds_read_b64_tr_b16 v[114:115], v154 offset:1536
    v_mfma_f32_16x16x32_bf16 v[40:43], v[124:127], v[96:99], v[40:43]
    ds_read_b64_tr_b16 v[116:117], v155 offset:288
    v_mfma_f32_16x16x32_bf16 v[44:47], v[124:127], v[100:103], v[44:47]
    ds_read_b64_tr_b16 v[118:119], v155 offset:1568
    s_waitcnt lgkmcnt(8)
    v_mfma_f32_16x16x32_bf16 v[48:51], v[128:131], v[96:99], v[48:51]
    ds_read_b128 v[104:107], v149 offset:0
    ds_read_b128 v[108:111], v149 offset:2048
    v_mfma_f32_16x16x32_bf16 v[52:55], v[128:131], v[100:103], v[52:55]
    ds_read_b64_tr_b16 v[120:121], v154 offset:10240
    ds_read_b64_tr_b16 v[122:123], v154 offset:11520
    v_mfma_f32_16x16x32_bf16 v[56:59], v[132:135], v[96:99], v[56:59]
    ds_read_b64_tr_b16 v[124:125], v155 offset:10272
    v_mfma_f32_16x16x32_bf16 v[60:63], v[132:135], v[100:103], v[60:63]
    ds_read_b64_tr_b16 v[126:127], v155 offset:11552
    s_waitcnt lgkmcnt(10)
    v_mfma_f32_16x16x32_bf16 v[64:67], v[136:139], v[96:99], v[64:67]
    ds_read_b64_tr_b16 v[128:129], v154 offset:10304
    v_mfma_f32_16x16x32_bf16 v[68:71], v[136:139], v[100:103], v[68:71]
    ds_read_b64_tr_b16 v[130:131], v154 offset:11584
    v_mfma_f32_16x16x32_bf16 v[72:75], v[140:143], v[96:99], v[72:75]
    ds_read_b64_tr_b16 v[132:133], v155 offset:10336
    v_mfma_f32_16x16x32_bf16 v[76:79], v[140:143], v[100:103], v[76:79]
    ds_read_b64_tr_b16 v[134:135], v155 offset:11616
    s_waitcnt lgkmcnt(10)
    v_mfma_f32_16x16x32_bf16 v[80:83], v[112:115], v[96:99], v[80:83]
    ds_read_b64_tr_b16 v[136:137], v154 offset:10368
    v_mfma_f32_16x16x32_bf16 v[84:87], v[112:115], v[100:103], v[84:87]
    ds_read_b64_tr_b16 v[138:139], v154 offset:11648
    v_mfma_f32_16x16x32_bf16 v[88:91], v[116:119], v[96:99], v[88:91]
    ds_read_b64_tr_b16 v[140:141], v155 offset:10400
    v_mfma_f32_16x16x32_bf16 v[92:95], v[116:119], v[100:103], v[92:95]
    ds_read_b64_tr_b16 v[142:143], v155 offset:11680
    s_waitcnt lgkmcnt(8)
    v_mfma_f32_16x16x32_bf16 v[16:19], v[120:123], v[104:107], v[16:19]
    ds_read_b64_tr_b16 v[112:113], v154 offset:10432
    v_mfma_f32_16x16x32_bf16 v[20:23], v[120:123], v[108:111], v[20:23]
    ds_read_b64_tr_b16 v[114:115], v154 offset:11712
    v_mfma_f32_16x16x32_bf16 v[24:27], v[124:127], v[104:107], v[24:27]
    ds_read_b64_tr_b16 v[116:117], v155 offset:10464
    v_mfma_f32_16x16x32_bf16 v[28:31], v[124:127], v[108:111], v[28:31]
    ds_read_b64_tr_b16 v[118:119], v155 offset:11744
    s_waitcnt lgkmcnt(8)
    v_mfma_f32_16x16x32_bf16 v[32:35], v[128:131], v[104:107], v[32:35]
    ds_read_b64_tr_b16 v[120:121], v154 offset:10496
    v_mfma_f32_16x16x32_bf16 v[36:39], v[128:131], v[108:111], v[36:39]
    ds_read_b64_tr_b16 v[122:123], v154 offset:11776
    v_mfma_f32_16x16x32_bf16 v[40:43], v[132:135], v[104:107], v[40:43]
    ds_read_b64_tr_b16 v[124:125], v155 offset:10528
    v_mfma_f32_16x16x32_bf16 v[44:47], v[132:135], v[108:111], v[44:47]
    ds_read_b64_tr_b16 v[126:127], v155 offset:11808
    s_waitcnt lgkmcnt(8)
    v_mfma_f32_16x16x32_bf16 v[48:51], v[136:139], v[104:107], v[48:51]
    v_mfma_f32_16x16x32_bf16 v[52:55], v[136:139], v[108:111], v[52:55]
    v_mfma_f32_16x16x32_bf16 v[56:59], v[140:143], v[104:107], v[56:59]
    v_mfma_f32_16x16x32_bf16 v[60:63], v[140:143], v[108:111], v[60:63]
    s_waitcnt lgkmcnt(4)
    v_mfma_f32_16x16x32_bf16 v[64:67], v[112:115], v[104:107], v[64:67]
    v_mfma_f32_16x16x32_bf16 v[68:71], v[112:115], v[108:111], v[68:71]
    s_waitcnt lgkmcnt(0)
    s_barrier
    v_mfma_f32_16x16x32_bf16 v[72:75], v[116:119], v[104:107], v[72:75]
    ds_read_b128 v[96:99], v144 offset:0
    ds_read_b128 v[100:103], v144 offset:2048
    v_mfma_f32_16x16x32_bf16 v[76:79], v[116:119], v[108:111], v[76:79]
    ds_read_b64_tr_b16 v[128:129], v150 offset:0
    ds_read_b64_tr_b16 v[130:131], v150 offset:1280
    v_mfma_f32_16x16x32_bf16 v[80:83], v[120:123], v[104:107], v[80:83]
    ds_read_b64_tr_b16 v[132:133], v151 offset:32
    ds_read_b64_tr_b16 v[134:135], v151 offset:1312
    v_mfma_f32_16x16x32_bf16 v[84:87], v[120:123], v[108:111], v[84:87]
    ds_read_b64_tr_b16 v[136:137], v150 offset:64
    ds_read_b64_tr_b16 v[138:139], v150 offset:1344
    v_mfma_f32_16x16x32_bf16 v[88:91], v[124:127], v[104:107], v[88:91]
    ds_read_b64_tr_b16 v[140:141], v151 offset:96
    ds_read_b64_tr_b16 v[142:143], v151 offset:1376
    v_mfma_f32_16x16x32_bf16 v[92:95], v[124:127], v[108:111], v[92:95]
    ds_read_b64_tr_b16 v[112:113], v150 offset:128
    ds_read_b64_tr_b16 v[114:115], v150 offset:1408
    s_waitcnt lgkmcnt(6)
    v_mfma_f32_16x16x32_bf16 v[16:19], v[128:131], v[96:99], v[16:19]
    ds_read_b64_tr_b16 v[116:117], v151 offset:160
    ds_read_b64_tr_b16 v[118:119], v151 offset:1440
    v_mfma_f32_16x16x32_bf16 v[20:23], v[128:131], v[100:103], v[20:23]
    ds_read_b64_tr_b16 v[120:121], v150 offset:192
    ds_read_b64_tr_b16 v[122:123], v150 offset:1472
    v_mfma_f32_16x16x32_bf16 v[24:27], v[132:135], v[96:99], v[24:27]
    ds_read_b64_tr_b16 v[124:125], v151 offset:224
    v_mfma_f32_16x16x32_bf16 v[28:31], v[132:135], v[100:103], v[28:31]
    ds_read_b64_tr_b16 v[126:127], v151 offset:1504
    s_waitcnt lgkmcnt(8)
    v_mfma_f32_16x16x32_bf16 v[32:35], v[136:139], v[96:99], v[32:35]
    ds_read_b64_tr_b16 v[128:129], v150 offset:256
    v_mfma_f32_16x16x32_bf16 v[36:39], v[136:139], v[100:103], v[36:39]
    ds_read_b64_tr_b16 v[130:131], v150 offset:1536
    v_mfma_f32_16x16x32_bf16 v[40:43], v[140:143], v[96:99], v[40:43]
    ds_read_b64_tr_b16 v[132:133], v151 offset:288
    v_mfma_f32_16x16x32_bf16 v[44:47], v[140:143], v[100:103], v[44:47]
    ds_read_b64_tr_b16 v[134:135], v151 offset:1568
    s_waitcnt lgkmcnt(8)
    v_mfma_f32_16x16x32_bf16 v[48:51], v[112:115], v[96:99], v[48:51]
    ds_read_b128 v[104:107], v145 offset:0
    ds_read_b128 v[108:111], v145 offset:2048
    v_mfma_f32_16x16x32_bf16 v[52:55], v[112:115], v[100:103], v[52:55]
    ds_read_b64_tr_b16 v[136:137], v150 offset:10240
    ds_read_b64_tr_b16 v[138:139], v150 offset:11520
    v_mfma_f32_16x16x32_bf16 v[56:59], v[116:119], v[96:99], v[56:59]
    ds_read_b64_tr_b16 v[140:141], v151 offset:10272
    v_mfma_f32_16x16x32_bf16 v[60:63], v[116:119], v[100:103], v[60:63]
    ds_read_b64_tr_b16 v[142:143], v151 offset:11552
    s_waitcnt lgkmcnt(10)
    v_mfma_f32_16x16x32_bf16 v[64:67], v[120:123], v[96:99], v[64:67]
    ds_read_b64_tr_b16 v[112:113], v150 offset:10304
    v_mfma_f32_16x16x32_bf16 v[68:71], v[120:123], v[100:103], v[68:71]
    ds_read_b64_tr_b16 v[114:115], v150 offset:11584
    v_mfma_f32_16x16x32_bf16 v[72:75], v[124:127], v[96:99], v[72:75]
    ds_read_b64_tr_b16 v[116:117], v151 offset:10336
    v_mfma_f32_16x16x32_bf16 v[76:79], v[124:127], v[100:103], v[76:79]
    ds_read_b64_tr_b16 v[118:119], v151 offset:11616
    s_waitcnt lgkmcnt(10)
    v_mfma_f32_16x16x32_bf16 v[80:83], v[128:131], v[96:99], v[80:83]
    ds_read_b64_tr_b16 v[120:121], v150 offset:10368
    v_mfma_f32_16x16x32_bf16 v[84:87], v[128:131], v[100:103], v[84:87]
    ds_read_b64_tr_b16 v[122:123], v150 offset:11648
    v_mfma_f32_16x16x32_bf16 v[88:91], v[132:135], v[96:99], v[88:91]
    ds_read_b64_tr_b16 v[124:125], v151 offset:10400
    v_mfma_f32_16x16x32_bf16 v[92:95], v[132:135], v[100:103], v[92:95]
    ds_read_b64_tr_b16 v[126:127], v151 offset:11680
    s_waitcnt lgkmcnt(8)
    v_mfma_f32_16x16x32_bf16 v[16:19], v[136:139], v[104:107], v[16:19]
    ds_read_b64_tr_b16 v[128:129], v150 offset:10432
    v_mfma_f32_16x16x32_bf16 v[20:23], v[136:139], v[108:111], v[20:23]
    ds_read_b64_tr_b16 v[130:131], v150 offset:11712
    v_mfma_f32_16x16x32_bf16 v[24:27], v[140:143], v[104:107], v[24:27]
    ds_read_b64_tr_b16 v[132:133], v151 offset:10464
    v_mfma_f32_16x16x32_bf16 v[28:31], v[140:143], v[108:111], v[28:31]
    ds_read_b64_tr_b16 v[134:135], v151 offset:11744
    s_waitcnt lgkmcnt(8)
    v_mfma_f32_16x16x32_bf16 v[32:35], v[112:115], v[104:107], v[32:35]
    ds_read_b64_tr_b16 v[136:137], v150 offset:10496
    v_mfma_f32_16x16x32_bf16 v[36:39], v[112:115], v[108:111], v[36:39]
    ds_read_b64_tr_b16 v[138:139], v150 offset:11776
    v_mfma_f32_16x16x32_bf16 v[40:43], v[116:119], v[104:107], v[40:43]
    ds_read_b64_tr_b16 v[140:141], v151 offset:10528
    v_mfma_f32_16x16x32_bf16 v[44:47], v[116:119], v[108:111], v[44:47]
    ds_read_b64_tr_b16 v[142:143], v151 offset:11808
    s_waitcnt lgkmcnt(8)
    v_mfma_f32_16x16x32_bf16 v[48:51], v[120:123], v[104:107], v[48:51]
    v_mfma_f32_16x16x32_bf16 v[52:55], v[120:123], v[108:111], v[52:55]
    v_mfma_f32_16x16x32_bf16 v[56:59], v[124:127], v[104:107], v[56:59]
    v_mfma_f32_16x16x32_bf16 v[60:63], v[124:127], v[108:111], v[60:63]
    s_waitcnt lgkmcnt(4)
    v_mfma_f32_16x16x32_bf16 v[64:67], v[128:131], v[104:107], v[64:67]
    v_mfma_f32_16x16x32_bf16 v[68:71], v[128:131], v[108:111], v[68:71]
    s_waitcnt lgkmcnt(0)
    s_barrier
    v_mfma_f32_16x16x32_bf16 v[72:75], v[132:135], v[104:107], v[72:75]
    ds_read_b128 v[96:99], v146 offset:0
    ds_read_b128 v[100:103], v146 offset:2048
    v_mfma_f32_16x16x32_bf16 v[76:79], v[132:135], v[108:111], v[76:79]
    ds_read_b64_tr_b16 v[112:113], v152 offset:0
    ds_read_b64_tr_b16 v[114:115], v152 offset:1280
    v_mfma_f32_16x16x32_bf16 v[80:83], v[136:139], v[104:107], v[80:83]
    ds_read_b64_tr_b16 v[116:117], v153 offset:32
    ds_read_b64_tr_b16 v[118:119], v153 offset:1312
    v_mfma_f32_16x16x32_bf16 v[84:87], v[136:139], v[108:111], v[84:87]
    ds_read_b64_tr_b16 v[120:121], v152 offset:64
    ds_read_b64_tr_b16 v[122:123], v152 offset:1344
    v_mfma_f32_16x16x32_bf16 v[88:91], v[140:143], v[104:107], v[88:91]
    ds_read_b64_tr_b16 v[124:125], v153 offset:96
    ds_read_b64_tr_b16 v[126:127], v153 offset:1376
    v_mfma_f32_16x16x32_bf16 v[92:95], v[140:143], v[108:111], v[92:95]
    ds_read_b64_tr_b16 v[128:129], v152 offset:128
    ds_read_b64_tr_b16 v[130:131], v152 offset:1408
    s_waitcnt lgkmcnt(6)
    v_mfma_f32_16x16x32_bf16 v[16:19], v[112:115], v[96:99], v[16:19]
    ds_read_b64_tr_b16 v[132:133], v153 offset:160
    ds_read_b64_tr_b16 v[134:135], v153 offset:1440
    v_mfma_f32_16x16x32_bf16 v[20:23], v[112:115], v[100:103], v[20:23]
    ds_read_b64_tr_b16 v[136:137], v152 offset:192
    ds_read_b64_tr_b16 v[138:139], v152 offset:1472
    v_mfma_f32_16x16x32_bf16 v[24:27], v[116:119], v[96:99], v[24:27]
    ds_read_b64_tr_b16 v[140:141], v153 offset:224
    v_mfma_f32_16x16x32_bf16 v[28:31], v[116:119], v[100:103], v[28:31]
    ds_read_b64_tr_b16 v[142:143], v153 offset:1504
    s_waitcnt lgkmcnt(8)
    v_mfma_f32_16x16x32_bf16 v[32:35], v[120:123], v[96:99], v[32:35]
    ds_read_b64_tr_b16 v[112:113], v152 offset:256
    v_mfma_f32_16x16x32_bf16 v[36:39], v[120:123], v[100:103], v[36:39]
    ds_read_b64_tr_b16 v[114:115], v152 offset:1536
    v_mfma_f32_16x16x32_bf16 v[40:43], v[124:127], v[96:99], v[40:43]
    ds_read_b64_tr_b16 v[116:117], v153 offset:288
    v_mfma_f32_16x16x32_bf16 v[44:47], v[124:127], v[100:103], v[44:47]
    ds_read_b64_tr_b16 v[118:119], v153 offset:1568
    s_waitcnt lgkmcnt(8)
    v_mfma_f32_16x16x32_bf16 v[48:51], v[128:131], v[96:99], v[48:51]
    ds_read_b128 v[104:107], v147 offset:0
    ds_read_b128 v[108:111], v147 offset:2048
    v_mfma_f32_16x16x32_bf16 v[52:55], v[128:131], v[100:103], v[52:55]
    ds_read_b64_tr_b16 v[120:121], v152 offset:10240
    ds_read_b64_tr_b16 v[122:123], v152 offset:11520
    v_mfma_f32_16x16x32_bf16 v[56:59], v[132:135], v[96:99], v[56:59]
    ds_read_b64_tr_b16 v[124:125], v153 offset:10272
    v_mfma_f32_16x16x32_bf16 v[60:63], v[132:135], v[100:103], v[60:63]
    ds_read_b64_tr_b16 v[126:127], v153 offset:11552
    s_waitcnt lgkmcnt(10)
    v_mfma_f32_16x16x32_bf16 v[64:67], v[136:139], v[96:99], v[64:67]
    ds_read_b64_tr_b16 v[128:129], v152 offset:10304
    v_mfma_f32_16x16x32_bf16 v[68:71], v[136:139], v[100:103], v[68:71]
    ds_read_b64_tr_b16 v[130:131], v152 offset:11584
    v_mfma_f32_16x16x32_bf16 v[72:75], v[140:143], v[96:99], v[72:75]
    ds_read_b64_tr_b16 v[132:133], v153 offset:10336
    v_mfma_f32_16x16x32_bf16 v[76:79], v[140:143], v[100:103], v[76:79]
    ds_read_b64_tr_b16 v[134:135], v153 offset:11616
    s_waitcnt lgkmcnt(10)
    v_mfma_f32_16x16x32_bf16 v[80:83], v[112:115], v[96:99], v[80:83]
    ds_read_b64_tr_b16 v[136:137], v152 offset:10368
    v_mfma_f32_16x16x32_bf16 v[84:87], v[112:115], v[100:103], v[84:87]
    ds_read_b64_tr_b16 v[138:139], v152 offset:11648
    v_mfma_f32_16x16x32_bf16 v[88:91], v[116:119], v[96:99], v[88:91]
    ds_read_b64_tr_b16 v[140:141], v153 offset:10400
    v_mfma_f32_16x16x32_bf16 v[92:95], v[116:119], v[100:103], v[92:95]
    ds_read_b64_tr_b16 v[142:143], v153 offset:11680
    s_waitcnt lgkmcnt(8)
    v_mfma_f32_16x16x32_bf16 v[16:19], v[120:123], v[104:107], v[16:19]
    ds_read_b64_tr_b16 v[112:113], v152 offset:10432
    v_mfma_f32_16x16x32_bf16 v[20:23], v[120:123], v[108:111], v[20:23]
    ds_read_b64_tr_b16 v[114:115], v152 offset:11712
    v_mfma_f32_16x16x32_bf16 v[24:27], v[124:127], v[104:107], v[24:27]
    ds_read_b64_tr_b16 v[116:117], v153 offset:10464
    v_mfma_f32_16x16x32_bf16 v[28:31], v[124:127], v[108:111], v[28:31]
    ds_read_b64_tr_b16 v[118:119], v153 offset:11744
    s_waitcnt lgkmcnt(8)
    v_mfma_f32_16x16x32_bf16 v[32:35], v[128:131], v[104:107], v[32:35]
    ds_read_b64_tr_b16 v[120:121], v152 offset:10496
    v_mfma_f32_16x16x32_bf16 v[36:39], v[128:131], v[108:111], v[36:39]
    ds_read_b64_tr_b16 v[122:123], v152 offset:11776
    v_mfma_f32_16x16x32_bf16 v[40:43], v[132:135], v[104:107], v[40:43]
    ds_read_b64_tr_b16 v[124:125], v153 offset:10528
    v_mfma_f32_16x16x32_bf16 v[44:47], v[132:135], v[108:111], v[44:47]
    ds_read_b64_tr_b16 v[126:127], v153 offset:11808
    s_waitcnt lgkmcnt(8)
    v_mfma_f32_16x16x32_bf16 v[48:51], v[136:139], v[104:107], v[48:51]
    v_mfma_f32_16x16x32_bf16 v[52:55], v[136:139], v[108:111], v[52:55]
    v_mfma_f32_16x16x32_bf16 v[56:59], v[140:143], v[104:107], v[56:59]
    v_mfma_f32_16x16x32_bf16 v[60:63], v[140:143], v[108:111], v[60:63]
    s_waitcnt lgkmcnt(4)
    v_mfma_f32_16x16x32_bf16 v[64:67], v[112:115], v[104:107], v[64:67]
    v_mfma_f32_16x16x32_bf16 v[68:71], v[112:115], v[108:111], v[68:71]
    s_waitcnt lgkmcnt(0)
    s_barrier
    s_cmp_eq_u32 s40, 0
    s_cbranch_scc0 NOLOOK_1
    v_mov_b32 v2, 0
    buffer_load_dword v14, v2, s[32:35], 0 offen sc1
NOLOOK_1:
    v_mfma_f32_16x16x32_bf16 v[72:75], v[116:119], v[104:107], v[72:75]
    ds_read_b128 v[96:99], v148 offset:0
    ds_read_b128 v[100:103], v148 offset:2048
    v_mfma_f32_16x16x32_bf16 v[76:79], v[116:119], v[108:111], v[76:79]
    ds_read_b64_tr_b16 v[128:129], v154 offset:0
    ds_read_b64_tr_b16 v[130:131], v154 offset:1280
    v_mfma_f32_16x16x32_bf16 v[80:83], v[120:123], v[104:107], v[80:83]
    ds_read_b64_tr_b16 v[132:133], v155 offset:32
    ds_read_b64_tr_b16 v[134:135], v155 offset:1312
    v_mfma_f32_16x16x32_bf16 v[84:87], v[120:123], v[108:111], v[84:87]
    ds_read_b64_tr_b16 v[136:137], v154 offset:64
    ds_read_b64_tr_b16 v[138:139], v154 offset:1344
    v_mfma_f32_16x16x32_bf16 v[88:91], v[124:127], v[104:107], v[88:91]
    ds_read_b64_tr_b16 v[140:141], v155 offset:96
    ds_read_b64_tr_b16 v[142:143], v155 offset:1376
    v_mfma_f32_16x16x32_bf16 v[92:95], v[124:127], v[108:111], v[92:95]
    ds_read_b64_tr_b16 v[112:113], v154 offset:128
    ds_read_b64_tr_b16 v[114:115], v154 offset:1408
    s_waitcnt lgkmcnt(6)
    v_mfma_f32_16x16x32_bf16 v[16:19], v[128:131], v[96:99], v[16:19]
    ds_read_b64_tr_b16 v[116:117], v155 offset:160
    ds_read_b64_tr_b16 v[118:119], v155 offset:1440
    v_mfma_f32_16x16x32_bf16 v[20:23], v[128:131], v[100:103], v[20:23]
    ds_read_b64_tr_b16 v[120:121], v154 offset:192
    ds_read_b64_tr_b16 v[122:123], v154 offset:1472
    v_mfma_f32_16x16x32_bf16 v[24:27], v[132:135], v[96:99], v[24:27]
    ds_read_b64_tr_b16 v[124:125], v155 offset:224
    v_mfma_f32_16x16x32_bf16 v[28:31], v[132:135], v[100:103], v[28:31]
    ds_read_b64_tr_b16 v[126:127], v155 offset:1504
    s_waitcnt lgkmcnt(8)
    v_mfma_f32_16x16x32_bf16 v[32:35], v[136:139], v[96:99], v[32:35]
    ds_read_b64_tr_b16 v[128:129], v154 offset:256
    v_mfma_f32_16x16x32_bf16 v[36:39], v[136:139], v[100:103], v[36:39]
    ds_read_b64_tr_b16 v[130:131], v154 offset:1536
    v_mfma_f32_16x16x32_bf16 v[40:43], v[140:143], v[96:99], v[40:43]
    ds_read_b64_tr_b16 v[132:133], v155 offset:288
    v_mfma_f32_16x16x32_bf16 v[44:47], v[140:143], v[100:103], v[44:47]
    ds_read_b64_tr_b16 v[134:135], v155 offset:1568
    s_waitcnt lgkmcnt(8)
    v_mfma_f32_16x16x32_bf16 v[48:51], v[112:115], v[96:99], v[48:51]
    ds_read_b128 v[104:107], v149 offset:0
    ds_read_b128 v[108:111], v149 offset:2048
    v_mfma_f32_16x16x32_bf16 v[52:55], v[112:115], v[100:103], v[52:55]
    ds_read_b64_tr_b16 v[136:137], v154 offset:10240
    ds_read_b64_tr_b16 v[138:139], v154 offset:11520
    v_mfma_f32_16x16x32_bf16 v[56:59], v[116:119], v[96:99], v[56:59]
    ds_read_b64_tr_b16 v[140:141], v155 offset:10272
    v_mfma_f32_16x16x32_bf16 v[60:63], v[116:119], v[100:103], v[60:63]
    ds_read_b64_tr_b16 v[142:143], v155 offset:11552
    s_waitcnt lgkmcnt(10)
    v_mfma_f32_16x16x32_bf16 v[64:67], v[120:123], v[96:99], v[64:67]
    ds_read_b64_tr_b16 v[112:113], v154 offset:10304
    v_mfma_f32_16x16x32_bf16 v[68:71], v[120:123], v[100:103], v[68:71]
    ds_read_b64_tr_b16 v[114:115], v154 offset:11584
    v_mfma_f32_16x16x32_bf16 v[72:75], v[124:127], v[96:99], v[72:75]
    ds_read_b64_tr_b16 v[116:117], v155 offset:10336
    v_mfma_f32_16x16x32_bf16 v[76:79], v[124:127], v[100:103], v[76:79]
    ds_read_b64_tr_b16 v[118:119], v155 offset:11616
    s_waitcnt lgkmcnt(10)
    v_mfma_f32_16x16x32_bf16 v[80:83], v[128:131], v[96:99], v[80:83]
    ds_read_b64_tr_b16 v[120:121], v154 offset:10368
    v_mfma_f32_16x16x32_bf16 v[84:87], v[128:131], v[100:103], v[84:87]
    ds_read_b64_tr_b16 v[122:123], v154 offset:11648
    v_mfma_f32_16x16x32_bf16 v[88:91], v[132:135], v[96:99], v[88:91]
    ds_read_b64_tr_b16 v[124:125], v155 offset:10400
    v_mfma_f32_16x16x32_bf16 v[92:95], v[132:135], v[100:103], v[92:95]
    ds_read_b64_tr_b16 v[126:127], v155 offset:11680
    s_waitcnt lgkmcnt(8)
    v_mfma_f32_16x16x32_bf16 v[16:19], v[136:139], v[104:107], v[16:19]
    ds_read_b64_tr_b16 v[128:129], v154 offset:10432
    v_mfma_f32_16x16x32_bf16 v[20:23], v[136:139], v[108:111], v[20:23]
    ds_read_b64_tr_b16 v[130:131], v154 offset:11712
    v_mfma_f32_16x16x32_bf16 v[24:27], v[140:143], v[104:107], v[24:27]
    ds_read_b64_tr_b16 v[132:133], v155 offset:10464
    v_mfma_f32_16x16x32_bf16 v[28:31], v[140:143], v[108:111], v[28:31]
    ds_read_b64_tr_b16 v[134:135], v155 offset:11744
    s_waitcnt lgkmcnt(8)
    v_mfma_f32_16x16x32_bf16 v[32:35], v[112:115], v[104:107], v[32:35]
    ds_read_b64_tr_b16 v[136:137], v154 offset:10496
    v_mfma_f32_16x16x32_bf16 v[36:39], v[112:115], v[108:111], v[36:39]
    ds_read_b64_tr_b16 v[138:139], v154 offset:11776
    v_mfma_f32_16x16x32_bf16 v[40:43], v[116:119], v[104:107], v[40:43]
    ds_read_b64_tr_b16 v[140:141], v155 offset:10528
    v_mfma_f32_16x16x32_bf16 v[44:47], v[116:119], v[108:111], v[44:47]
    ds_read_b64_tr_b16 v[142:143], v155 offset:11808
    s_waitcnt lgkmcnt(8)
    v_mfma_f32_16x16x32_bf16 v[48:51], v[120:123], v[104:107], v[48:51]
    v_mfma_f32_16x16x32_bf16 v[52:55], v[120:123], v[108:111], v[52:55]
    v_mfma_f32_16x16x32_bf16 v[56:59], v[124:127], v[104:107], v[56:59]
    v_mfma_f32_16x16x32_bf16 v[60:63], v[124:127], v[108:111], v[60:63]
    s_waitcnt lgkmcnt(4)
    v_mfma_f32_16x16x32_bf16 v[64:67], v[128:131], v[104:107], v[64:67]
    v_mfma_f32_16x16x32_bf16 v[68:71], v[128:131], v[108:111], v[68:71]
    s_waitcnt lgkmcnt(0)
    s_barrier
    v_mfma_f32_16x16x32_bf16 v[72:75], v[132:135], v[104:107], v[72:75]
    ds_read_b128 v[96:99], v144 offset:0
    ds_read_b128 v[100:103], v144 offset:2048
    v_mfma_f32_16x16x32_bf16 v[76:79], v[132:135], v[108:111], v[76:79]
    ds_read_b64_tr_b16 v[112:113], v150 offset:0
    ds_read_b64_tr_b16 v[114:115], v150 offset:1280
    v_mfma_f32_16x16x32_bf16 v[80:83], v[136:139], v[104:107], v[80:83]
    ds_read_b64_tr_b16 v[116:117], v151 offset:32
    ds_read_b64_tr_b16 v[118:119], v151 offset:1312
    v_mfma_f32_16x16x32_bf16 v[84:87], v[136:139], v[108:111], v[84:87]
    ds_read_b64_tr_b16 v[120:121], v150 offset:64
    ds_read_b64_tr_b16 v[122:123], v150 offset:1344
    v_mfma_f32_16x16x32_bf16 v[88:91], v[140:143], v[104:107], v[88:91]
    ds_read_b64_tr_b16 v[124:125], v151 offset:96
    ds_read_b64_tr_b16 v[126:127], v151 offset:1376
    v_mfma_f32_16x16x32_bf16 v[92:95], v[140:143], v[108:111], v[92:95]
    ds_read_b64_tr_b16 v[128:129], v150 offset:128
    ds_read_b64_tr_b16 v[130:131], v150 offset:1408
    s_waitcnt lgkmcnt(6)
    v_mfma_f32_16x16x32_bf16 v[16:19], v[112:115], v[96:99], v[16:19]
    ds_read_b64_tr_b16 v[132:133], v151 offset:160
    ds_read_b64_tr_b16 v[134:135], v151 offset:1440
    v_mfma_f32_16x16x32_bf16 v[20:23], v[112:115], v[100:103], v[20:23]
    ds_read_b64_tr_b16 v[136:137], v150 offset:192
    ds_read_b64_tr_b16 v[138:139], v150 offset:1472
    v_mfma_f32_16x16x32_bf16 v[24:27], v[116:119], v[96:99], v[24:27]
    ds_read_b64_tr_b16 v[140:141], v151 offset:224
    v_mfma_f32_16x16x32_bf16 v[28:31], v[116:119], v[100:103], v[28:31]
    ds_read_b64_tr_b16 v[142:143], v151 offset:1504
    s_waitcnt lgkmcnt(8)
    v_mfma_f32_16x16x32_bf16 v[32:35], v[120:123], v[96:99], v[32:35]
    ds_read_b64_tr_b16 v[112:113], v150 offset:256
    v_mfma_f32_16x16x32_bf16 v[36:39], v[120:123], v[100:103], v[36:39]
    ds_read_b64_tr_b16 v[114:115], v150 offset:1536
    v_mfma_f32_16x16x32_bf16 v[40:43], v[124:127], v[96:99], v[40:43]
    ds_read_b64_tr_b16 v[116:117], v151 offset:288
    v_mfma_f32_16x16x32_bf16 v[44:47], v[124:127], v[100:103], v[44:47]
    ds_read_b64_tr_b16 v[118:119], v151 offset:1568
    s_waitcnt lgkmcnt(8)
    v_mfma_f32_16x16x32_bf16 v[48:51], v[128:131], v[96:99], v[48:51]
    ds_read_b128 v[104:107], v145 offset:0
    ds_read_b128 v[108:111], v145 offset:2048
    v_mfma_f32_16x16x32_bf16 v[52:55], v[128:131], v[100:103], v[52:55]
    ds_read_b64_tr_b16 v[120:121], v150 offset:10240
    ds_read_b64_tr_b16 v[122:123], v150 offset:11520
    v_mfma_f32_16x16x32_bf16 v[56:59], v[132:135], v[96:99], v[56:59]
    ds_read_b64_tr_b16 v[124:125], v151 offset:10272
    v_mfma_f32_16x16x32_bf16 v[60:63], v[132:135], v[100:103], v[60:63]
    ds_read_b64_tr_b16 v[126:127], v151 offset:11552
    s_waitcnt lgkmcnt(10)
    v_mfma_f32_16x16x32_bf16 v[64:67], v[136:139], v[96:99], v[64:67]
    ds_read_b64_tr_b16 v[128:129], v150 offset:10304
    v_mfma_f32_16x16x32_bf16 v[68:71], v[136:139], v[100:103], v[68:71]
    ds_read_b64_tr_b16 v[130:131], v150 offset:11584
    v_mfma_f32_16x16x32_bf16 v[72:75], v[140:143], v[96:99], v[72:75]
    ds_read_b64_tr_b16 v[132:133], v151 offset:10336
    v_mfma_f32_16x16x32_bf16 v[76:79], v[140:143], v[100:103], v[76:79]
    ds_read_b64_tr_b16 v[134:135], v151 offset:11616
    s_waitcnt lgkmcnt(10)
    v_mfma_f32_16x16x32_bf16 v[80:83], v[112:115], v[96:99], v[80:83]
    ds_read_b64_tr_b16 v[136:137], v150 offset:10368
    v_mfma_f32_16x16x32_bf16 v[84:87], v[112:115], v[100:103], v[84:87]
    ds_read_b64_tr_b16 v[138:139], v150 offset:11648
    v_mfma_f32_16x16x32_bf16 v[88:91], v[116:119], v[96:99], v[88:91]
    ds_read_b64_tr_b16 v[140:141], v151 offset:10400
    v_mfma_f32_16x16x32_bf16 v[92:95], v[116:119], v[100:103], v[92:95]
    ds_read_b64_tr_b16 v[142:143], v151 offset:11680
    s_waitcnt lgkmcnt(8)
    v_mfma_f32_16x16x32_bf16 v[16:19], v[120:123], v[104:107], v[16:19]
    ds_read_b64_tr_b16 v[112:113], v150 offset:10432
    v_mfma_f32_16x16x32_bf16 v[20:23], v[120:123], v[108:111], v[20:23]
    ds_read_b64_tr_b16 v[114:115], v150 offset:11712
    v_mfma_f32_16x16x32_bf16 v[24:27], v[124:127], v[104:107], v[24:27]
    ds_read_b64_tr_b16 v[116:117], v151 offset:10464
    v_mfma_f32_16x16x32_bf16 v[28:31], v[124:127], v[108:111], v[28:31]
    ds_read_b64_tr_b16 v[118:119], v151 offset:11744
    s_waitcnt lgkmcnt(8)
    v_mfma_f32_16x16x32_bf16 v[32:35], v[128:131], v[104:107], v[32:35]
    ds_read_b64_tr_b16 v[120:121], v150 offset:10496
    v_mfma_f32_16x16x32_bf16 v[36:39], v[128:131], v[108:111], v[36:39]
    ds_read_b64_tr_b16 v[122:123], v150 offset:11776
    v_mfma_f32_16x16x32_bf16 v[40:43], v[132:135], v[104:107], v[40:43]
    ds_read_b64_tr_b16 v[124:125], v151 offset:10528
    v_mfma_f32_16x16x32_bf16 v[44:47], v[132:135], v[108:111], v[44:47]
    ds_read_b64_tr_b16 v[126:127], v151 offset:11808
    s_waitcnt lgkmcnt(8)
    v_mfma_f32_16x16x32_bf16 v[48:51], v[136:139], v[104:107], v[48:51]
    v_mfma_f32_16x16x32_bf16 v[52:55], v[136:139], v[108:111], v[52:55]
    v_mfma_f32_16x16x32_bf16 v[56:59], v[140:143], v[104:107], v[56:59]
    v_mfma_f32_16x16x32_bf16 v[60:63], v[140:143], v[108:111], v[60:63]
    s_waitcnt lgkmcnt(4)
    v_mfma_f32_16x16x32_bf16 v[64:67], v[112:115], v[104:107], v[64:67]
    v_mfma_f32_16x16x32_bf16 v[68:71], v[112:115], v[108:111], v[68:71]
    s_waitcnt lgkmcnt(0)
    s_barrier
    v_mfma_f32_16x16x32_bf16 v[72:75], v[116:119], v[104:107], v[72:75]
    ds_read_b128 v[96:99], v146 offset:0
    ds_read_b128 v[100:103], v146 offset:2048
    v_mfma_f32_16x16x32_bf16 v[76:79], v[116:119], v[108:111], v[76:79]
    ds_read_b64_tr_b16 v[128:129], v152 offset:0
    ds_read_b64_tr_b16 v[130:131], v152 offset:1280
    v_mfma_f32_16x16x32_bf16 v[80:83], v[120:123], v[104:107], v[80:83]
    ds_read_b64_tr_b16 v[132:133], v153 offset:32
    ds_read_b64_tr_b16 v[134:135], v153 offset:1312
    v_mfma_f32_16x16x32_bf16 v[84:87], v[120:123], v[108:111], v[84:87]
    ds_read_b64_tr_b16 v[136:137], v152 offset:64
    ds_read_b64_tr_b16 v[138:139], v152 offset:1344
    v_mfma_f32_16x16x32_bf16 v[88:91], v[124:127], v[104:107], v[88:91]
    ds_read_b64_tr_b16 v[140:141], v153 offset:96
    ds_read_b64_tr_b16 v[142:143], v153 offset:1376
    v_mfma_f32_16x16x32_bf16 v[92:95], v[124:127], v[108:111], v[92:95]
    ds_read_b64_tr_b16 v[112:113], v152 offset:128
    ds_read_b64_tr_b16 v[114:115], v152 offset:1408
    s_waitcnt lgkmcnt(6)
    v_mfma_f32_16x16x32_bf16 v[16:19], v[128:131], v[96:99], v[16:19]
    ds_read_b64_tr_b16 v[116:117], v153 offset:160
    ds_read_b64_tr_b16 v[118:119], v153 offset:1440
    v_mfma_f32_16x16x32_bf16 v[20:23], v[128:131], v[100:103], v[20:23]
    ds_read_b64_tr_b16 v[120:121], v152 offset:192
    ds_read_b64_tr_b16 v[122:123], v152 offset:1472
    v_mfma_f32_16x16x32_bf16 v[24:27], v[132:135], v[96:99], v[24:27]
    ds_read_b64_tr_b16 v[124:125], v153 offset:224
    v_mfma_f32_16x16x32_bf16 v[28:31], v[132:135], v[100:103], v[28:31]
    ds_read_b64_tr_b16 v[126:127], v153 offset:1504
    s_waitcnt lgkmcnt(8)
    v_mfma_f32_16x16x32_bf16 v[32:35], v[136:139], v[96:99], v[32:35]
    ds_read_b64_tr_b16 v[128:129], v152 offset:256
    v_mfma_f32_16x16x32_bf16 v[36:39], v[136:139], v[100:103], v[36:39]
    ds_read_b64_tr_b16 v[130:131], v152 offset:1536
    v_mfma_f32_16x16x32_bf16 v[40:43], v[140:143], v[96:99], v[40:43]
    ds_read_b64_tr_b16 v[132:133], v153 offset:288
    v_mfma_f32_16x16x32_bf16 v[44:47], v[140:143], v[100:103], v[44:47]
    ds_read_b64_tr_b16 v[134:135], v153 offset:1568
    s_waitcnt lgkmcnt(8)
    v_mfma_f32_16x16x32_bf16 v[48:51], v[112:115], v[96:99], v[48:51]
    ds_read_b128 v[104:107], v147 offset:0
    ds_read_b128 v[108:111], v147 offset:2048
    v_mfma_f32_16x16x32_bf16 v[52:55], v[112:115], v[100:103], v[52:55]
    ds_read_b64_tr_b16 v[136:137], v152 offset:10240
    ds_read_b64_tr_b16 v[138:139], v152 offset:11520
    v_mfma_f32_16x16x32_bf16 v[56:59], v[116:119], v[96:99], v[56:59]
    ds_read_b64_tr_b16 v[140:141], v153 offset:10272
    v_mfma_f32_16x16x32_bf16 v[60:63], v[116:119], v[100:103], v[60:63]
    ds_read_b64_tr_b16 v[142:143], v153 offset:11552
    s_waitcnt lgkmcnt(10)
    v_mfma_f32_16x16x32_bf16 v[64:67], v[120:123], v[96:99], v[64:67]
    ds_read_b64_tr_b16 v[112:113], v152 offset:10304
    v_mfma_f32_16x16x32_bf16 v[68:71], v[120:123], v[100:103], v[68:71]
    ds_read_b64_tr_b16 v[114:115], v152 offset:11584
    v_mfma_f32_16x16x32_bf16 v[72:75], v[124:127], v[96:99], v[72:75]
    ds_read_b64_tr_b16 v[116:117], v153 offset:10336
    v_mfma_f32_16x16x32_bf16 v[76:79], v[124:127], v[100:103], v[76:79]
    ds_read_b64_tr_b16 v[118:119], v153 offset:11616
    s_waitcnt lgkmcnt(10)
    v_mfma_f32_16x16x32_bf16 v[80:83], v[128:131], v[96:99], v[80:83]
    ds_read_b64_tr_b16 v[120:121], v152 offset:10368
    v_mfma_f32_16x16x32_bf16 v[84:87], v[128:131], v[100:103], v[84:87]
    ds_read_b64_tr_b16 v[122:123], v152 offset:11648
    v_mfma_f32_16x16x32_bf16 v[88:91], v[132:135], v[96:99], v[88:91]
    ds_read_b64_tr_b16 v[124:125], v153 offset:10400
    v_mfma_f32_16x16x32_bf16 v[92:95], v[132:135], v[100:103], v[92:95]
    ds_read_b64_tr_b16 v[126:127], v153 offset:11680
    s_waitcnt lgkmcnt(8)
    v_mfma_f32_16x16x32_bf16 v[16:19], v[136:139], v[104:107], v[16:19]
    ds_read_b64_tr_b16 v[128:129], v152 offset:10432
    v_mfma_f32_16x16x32_bf16 v[20:23], v[136:139], v[108:111], v[20:23]
    ds_read_b64_tr_b16 v[130:131], v152 offset:11712
    v_mfma_f32_16x16x32_bf16 v[24:27], v[140:143], v[104:107], v[24:27]
    ds_read_b64_tr_b16 v[132:133], v153 offset:10464
    v_mfma_f32_16x16x32_bf16 v[28:31], v[140:143], v[108:111], v[28:31]
    ds_read_b64_tr_b16 v[134:135], v153 offset:11744
    s_waitcnt lgkmcnt(8)
    v_mfma_f32_16x16x32_bf16 v[32:35], v[112:115], v[104:107], v[32:35]
    ds_read_b64_tr_b16 v[136:137], v152 offset:10496
    v_mfma_f32_16x16x32_bf16 v[36:39], v[112:115], v[108:111], v[36:39]
    ds_read_b64_tr_b16 v[138:139], v152 offset:11776
    v_mfma_f32_16x16x32_bf16 v[40:43], v[116:119], v[104:107], v[40:43]
    ds_read_b64_tr_b16 v[140:141], v153 offset:10528
    v_mfma_f32_16x16x32_bf16 v[44:47], v[116:119], v[108:111], v[44:47]
    ds_read_b64_tr_b16 v[142:143], v153 offset:11808
    s_waitcnt lgkmcnt(8)
    v_mfma_f32_16x16x32_bf16 v[48:51], v[120:123], v[104:107], v[48:51]
    v_mfma_f32_16x16x32_bf16 v[52:55], v[120:123], v[108:111], v[52:55]
    v_mfma_f32_16x16x32_bf16 v[56:59], v[124:127], v[104:107], v[56:59]
    v_mfma_f32_16x16x32_bf16 v[60:63], v[124:127], v[108:111], v[60:63]
    s_waitcnt lgkmcnt(4)
    v_mfma_f32_16x16x32_bf16 v[64:67], v[128:131], v[104:107], v[64:67]
    v_mfma_f32_16x16x32_bf16 v[68:71], v[128:131], v[108:111], v[68:71]
    s_waitcnt lgkmcnt(0)
    s_barrier
    v_mfma_f32_16x16x32_bf16 v[72:75], v[132:135], v[104:107], v[72:75]
    ds_read_b128 v[96:99], v148 offset:0
    ds_read_b128 v[100:103], v148 offset:2048
    v_mfma_f32_16x16x32_bf16 v[76:79], v[132:135], v[108:111], v[76:79]
    ds_read_b64_tr_b16 v[112:113], v154 offset:0
    ds_read_b64_tr_b16 v[114:115], v154 offset:1280
    v_mfma_f32_16x16x32_bf16 v[80:83], v[136:139], v[104:107], v[80:83]
    ds_read_b64_tr_b16 v[116:117], v155 offset:32
    ds_read_b64_tr_b16 v[118:119], v155 offset:1312
    v_mfma_f32_16x16x32_bf16 v[84:87], v[136:139], v[108:111], v[84:87]
    ds_read_b64_tr_b16 v[120:121], v154 offset:64
    ds_read_b64_tr_b16 v[122:123], v154 offset:1344
    v_mfma_f32_16x16x32_bf16 v[88:91], v[140:143], v[104:107], v[88:91]
    ds_read_b64_tr_b16 v[124:125], v155 offset:96
    ds_read_b64_tr_b16 v[126:127], v155 offset:1376
    v_mfma_f32_16x16x32_bf16 v[92:95], v[140:143], v[108:111], v[92:95]
    ds_read_b64_tr_b16 v[128:129], v154 offset:128
    ds_read_b64_tr_b16 v[130:131], v154 offset:1408
    s_waitcnt lgkmcnt(6)
    v_mfma_f32_16x16x32_bf16 v[16:19], v[112:115], v[96:99], v[16:19]
    ds_read_b64_tr_b16 v[132:133], v155 offset:160
    ds_read_b64_tr_b16 v[134:135], v155 offset:1440
    v_mfma_f32_16x16x32_bf16 v[20:23], v[112:115], v[100:103], v[20:23]
    ds_read_b64_tr_b16 v[136:137], v154 offset:192
    ds_read_b64_tr_b16 v[138:139], v154 offset:1472
    v_mfma_f32_16x16x32_bf16 v[24:27], v[116:119], v[96:99], v[24:27]
    ds_read_b64_tr_b16 v[140:141], v155 offset:224
    v_mfma_f32_16x16x32_bf16 v[28:31], v[116:119], v[100:103], v[28:31]
    ds_read_b64_tr_b16 v[142:143], v155 offset:1504
    s_waitcnt lgkmcnt(8)
    v_mfma_f32_16x16x32_bf16 v[32:35], v[120:123], v[96:99], v[32:35]
    ds_read_b64_tr_b16 v[112:113], v154 offset:256
    v_mfma_f32_16x16x32_bf16 v[36:39], v[120:123], v[100:103], v[36:39]
    ds_read_b64_tr_b16 v[114:115], v154 offset:1536
    v_mfma_f32_16x16x32_bf16 v[40:43], v[124:127], v[96:99], v[40:43]
    ds_read_b64_tr_b16 v[116:117], v155 offset:288
    v_mfma_f32_16x16x32_bf16 v[44:47], v[124:127], v[100:103], v[44:47]
    ds_read_b64_tr_b16 v[118:119], v155 offset:1568
    s_waitcnt lgkmcnt(8)
    v_mfma_f32_16x16x32_bf16 v[48:51], v[128:131], v[96:99], v[48:51]
    ds_read_b128 v[104:107], v149 offset:0
    ds_read_b128 v[108:111], v149 offset:2048
    v_mfma_f32_16x16x32_bf16 v[52:55], v[128:131], v[100:103], v[52:55]
    ds_read_b64_tr_b16 v[120:121], v154 offset:10240
    ds_read_b64_tr_b16 v[122:123], v154 offset:11520
    v_mfma_f32_16x16x32_bf16 v[56:59], v[132:135], v[96:99], v[56:59]
    ds_read_b64_tr_b16 v[124:125], v155 offset:10272
    v_mfma_f32_16x16x32_bf16 v[60:63], v[132:135], v[100:103], v[60:63]
    ds_read_b64_tr_b16 v[126:127], v155 offset:11552
    s_waitcnt lgkmcnt(10)
    v_mfma_f32_16x16x32_bf16 v[64:67], v[136:139], v[96:99], v[64:67]
    ds_read_b64_tr_b16 v[128:129], v154 offset:10304
    v_mfma_f32_16x16x32_bf16 v[68:71], v[136:139], v[100:103], v[68:71]
    ds_read_b64_tr_b16 v[130:131], v154 offset:11584
    v_mfma_f32_16x16x32_bf16 v[72:75], v[140:143], v[96:99], v[72:75]
    ds_read_b64_tr_b16 v[132:133], v155 offset:10336
    v_mfma_f32_16x16x32_bf16 v[76:79], v[140:143], v[100:103], v[76:79]
    ds_read_b64_tr_b16 v[134:135], v155 offset:11616
    s_waitcnt lgkmcnt(10)
    v_mfma_f32_16x16x32_bf16 v[80:83], v[112:115], v[96:99], v[80:83]
    ds_read_b64_tr_b16 v[136:137], v154 offset:10368
    v_mfma_f32_16x16x32_bf16 v[84:87], v[112:115], v[100:103], v[84:87]
    ds_read_b64_tr_b16 v[138:139], v154 offset:11648
    v_mfma_f32_16x16x32_bf16 v[88:91], v[116:119], v[96:99], v[88:91]
    ds_read_b64_tr_b16 v[140:141], v155 offset:10400
    v_mfma_f32_16x16x32_bf16 v[92:95], v[116:119], v[100:103], v[92:95]
    ds_read_b64_tr_b16 v[142:143], v155 offset:11680
    s_waitcnt lgkmcnt(8)
    v_mfma_f32_16x16x32_bf16 v[16:19], v[120:123], v[104:107], v[16:19]
    ds_read_b64_tr_b16 v[112:113], v154 offset:10432
    v_mfma_f32_16x16x32_bf16 v[20:23], v[120:123], v[108:111], v[20:23]
    ds_read_b64_tr_b16 v[114:115], v154 offset:11712
    v_mfma_f32_16x16x32_bf16 v[24:27], v[124:127], v[104:107], v[24:27]
    ds_read_b64_tr_b16 v[116:117], v155 offset:10464
    v_mfma_f32_16x16x32_bf16 v[28:31], v[124:127], v[108:111], v[28:31]
    ds_read_b64_tr_b16 v[118:119], v155 offset:11744
    s_waitcnt lgkmcnt(8)
    v_mfma_f32_16x16x32_bf16 v[32:35], v[128:131], v[104:107], v[32:35]
    ds_read_b64_tr_b16 v[120:121], v154 offset:10496
    v_mfma_f32_16x16x32_bf16 v[36:39], v[128:131], v[108:111], v[36:39]
    ds_read_b64_tr_b16 v[122:123], v154 offset:11776
    v_mfma_f32_16x16x32_bf16 v[40:43], v[132:135], v[104:107], v[40:43]
    ds_read_b64_tr_b16 v[124:125], v155 offset:10528
    v_mfma_f32_16x16x32_bf16 v[44:47], v[132:135], v[108:111], v[44:47]
    ds_read_b64_tr_b16 v[126:127], v155 offset:11808
    s_waitcnt lgkmcnt(8)
    v_mfma_f32_16x16x32_bf16 v[48:51], v[136:139], v[104:107], v[48:51]
    v_mfma_f32_16x16x32_bf16 v[52:55], v[136:139], v[108:111], v[52:55]
    v_mfma_f32_16x16x32_bf16 v[56:59], v[140:143], v[104:107], v[56:59]
    v_mfma_f32_16x16x32_bf16 v[60:63], v[140:143], v[108:111], v[60:63]
    s_waitcnt lgkmcnt(4)
    v_mfma_f32_16x16x32_bf16 v[64:67], v[112:115], v[104:107], v[64:67]
    v_mfma_f32_16x16x32_bf16 v[68:71], v[112:115], v[108:111], v[68:71]
    s_waitcnt lgkmcnt(0)
    s_barrier
    s_waitcnt vmcnt(0)
    s_cmp_eq_u32 s40, 0
    s_cbranch_scc0 INITE_3
    v_readfirstlane_b32 s61, v14
    s_nop 0
    s_cmp_ge_u32 s61, 48
    s_cbranch_scc1 INITOK_2
    v_mov_b32 v2, 0
    s_mov_b32 s63, 131072
    s_mov_b64 exec, 1
POLL_4:
    v_mov_b32 v3, 0
    buffer_atomic_add v3, v2, s[32:35], 0 offen sc0
    s_waitcnt vmcnt(0)
    v_readfirstlane_b32 s61, v3
    s_sub_u32 s63, s63, 1
    s_cbranch_scc1 POLLD_5
    s_cmp_ge_u32 s61, 48
    s_cbranch_scc1 POLLD_5
    s_sleep 32
    s_branch POLL_4
POLLD_5:
    s_mov_b64 exec, -1
INITOK_2:
    s_lshl_b32 s60, s44, 8
    s_add_u32 s55, s60, 163840
    v_mov_b32 v2, 0
    v_mov_b32 v197, 0
    s_mov_b64 exec, 1
    buffer_atomic_add v197, v2, s[36:39], s55 offen sc0
    s_mov_b64 exec, -1
INITE_3:
    v_mfma_f32_16x16x32_bf16 v[72:75], v[116:119], v[104:107], v[72:75]
    ds_read_b128 v[96:99], v144 offset:0
    ds_read_b128 v[100:103], v144 offset:2048
    v_mfma_f32_16x16x32_bf16 v[76:79], v[116:119], v[108:111], v[76:79]
    ds_read_b64_tr_b16 v[128:129], v150 offset:0
    ds_read_b64_tr_b16 v[130:131], v150 offset:1280
    v_mfma_f32_16x16x32_bf16 v[80:83], v[120:123], v[104:107], v[80:83]
    ds_read_b64_tr_b16 v[132:133], v151 offset:32
    ds_read_b64_tr_b16 v[134:135], v151 offset:1312
    v_mfma_f32_16x16x32_bf16 v[84:87], v[120:123], v[108:111], v[84:87]
    ds_read_b64_tr_b16 v[136:137], v150 offset:64
    ds_read_b64_tr_b16 v[138:139], v150 offset:1344
    v_mfma_f32_16x16x32_bf16 v[88:91], v[124:127], v[104:107], v[88:91]
    ds_read_b64_tr_b16 v[140:141], v151 offset:96
    ds_read_b64_tr_b16 v[142:143], v151 offset:1376
    v_mfma_f32_16x16x32_bf16 v[92:95], v[124:127], v[108:111], v[92:95]
    ds_read_b64_tr_b16 v[112:113], v150 offset:128
    ds_read_b64_tr_b16 v[114:115], v150 offset:1408
    s_waitcnt lgkmcnt(6)
    v_mfma_f32_16x16x32_bf16 v[16:19], v[128:131], v[96:99], v[16:19]
    ds_read_b64_tr_b16 v[116:117], v151 offset:160
    ds_read_b64_tr_b16 v[118:119], v151 offset:1440
    v_mfma_f32_16x16x32_bf16 v[20:23], v[128:131], v[100:103], v[20:23]
    ds_read_b64_tr_b16 v[120:121], v150 offset:192
    ds_read_b64_tr_b16 v[122:123], v150 offset:1472
    v_mfma_f32_16x16x32_bf16 v[24:27], v[132:135], v[96:99], v[24:27]
    ds_read_b64_tr_b16 v[124:125], v151 offset:224
    v_mfma_f32_16x16x32_bf16 v[28:31], v[132:135], v[100:103], v[28:31]
    ds_read_b64_tr_b16 v[126:127], v151 offset:1504
    s_waitcnt lgkmcnt(8)
    v_mfma_f32_16x16x32_bf16 v[32:35], v[136:139], v[96:99], v[32:35]
    ds_read_b64_tr_b16 v[128:129], v150 offset:256
    v_mfma_f32_16x16x32_bf16 v[36:39], v[136:139], v[100:103], v[36:39]
    ds_read_b64_tr_b16 v[130:131], v150 offset:1536
    v_mfma_f32_16x16x32_bf16 v[40:43], v[140:143], v[96:99], v[40:43]
    ds_read_b64_tr_b16 v[132:133], v151 offset:288
    v_mfma_f32_16x16x32_bf16 v[44:47], v[140:143], v[100:103], v[44:47]
    ds_read_b64_tr_b16 v[134:135], v151 offset:1568
    s_waitcnt lgkmcnt(8)
    v_mfma_f32_16x16x32_bf16 v[48:51], v[112:115], v[96:99], v[48:51]
    ds_read_b128 v[104:107], v145 offset:0
    ds_read_b128 v[108:111], v145 offset:2048
    v_mfma_f32_16x16x32_bf16 v[52:55], v[112:115], v[100:103], v[52:55]
    ds_read_b64_tr_b16 v[136:137], v150 offset:10240
    ds_read_b64_tr_b16 v[138:139], v150 offset:11520
    v_mfma_f32_16x16x32_bf16 v[56:59], v[116:119], v[96:99], v[56:59]
    ds_read_b64_tr_b16 v[140:141], v151 offset:10272
    v_mfma_f32_16x16x32_bf16 v[60:63], v[116:119], v[100:103], v[60:63]
    ds_read_b64_tr_b16 v[142:143], v151 offset:11552
    s_waitcnt lgkmcnt(10)
    v_mfma_f32_16x16x32_bf16 v[64:67], v[120:123], v[96:99], v[64:67]
    ds_read_b64_tr_b16 v[112:113], v150 offset:10304
    v_mfma_f32_16x16x32_bf16 v[68:71], v[120:123], v[100:103], v[68:71]
    ds_read_b64_tr_b16 v[114:115], v150 offset:11584
    v_mfma_f32_16x16x32_bf16 v[72:75], v[124:127], v[96:99], v[72:75]
    ds_read_b64_tr_b16 v[116:117], v151 offset:10336
    v_mfma_f32_16x16x32_bf16 v[76:79], v[124:127], v[100:103], v[76:79]
    ds_read_b64_tr_b16 v[118:119], v151 offset:11616
    s_waitcnt lgkmcnt(10)
    v_mfma_f32_16x16x32_bf16 v[80:83], v[128:131], v[96:99], v[80:83]
    ds_read_b64_tr_b16 v[120:121], v150 offset:10368
    v_mfma_f32_16x16x32_bf16 v[84:87], v[128:131], v[100:103], v[84:87]
    ds_read_b64_tr_b16 v[122:123], v150 offset:11648
    v_mfma_f32_16x16x32_bf16 v[88:91], v[132:135], v[96:99], v[88:91]
    ds_read_b64_tr_b16 v[124:125], v151 offset:10400
    v_mfma_f32_16x16x32_bf16 v[92:95], v[132:135], v[100:103], v[92:95]
    ds_read_b64_tr_b16 v[126:127], v151 offset:11680
    s_waitcnt lgkmcnt(8)
    v_mfma_f32_16x16x32_bf16 v[16:19], v[136:139], v[104:107], v[16:19]
    ds_read_b64_tr_b16 v[128:129], v150 offset:10432
    v_mfma_f32_16x16x32_bf16 v[20:23], v[136:139], v[108:111], v[20:23]
    ds_read_b64_tr_b16 v[130:131], v150 offset:11712
    v_mfma_f32_16x16x32_bf16 v[24:27], v[140:143], v[104:107], v[24:27]
    ds_read_b64_tr_b16 v[132:133], v151 offset:10464
    v_mfma_f32_16x16x32_bf16 v[28:31], v[140:143], v[108:111], v[28:31]
    ds_read_b64_tr_b16 v[134:135], v151 offset:11744
    s_waitcnt lgkmcnt(8)
    v_mfma_f32_16x16x32_bf16 v[32:35], v[112:115], v[104:107], v[32:35]
    ds_read_b64_tr_b16 v[136:137], v150 offset:10496
    v_mfma_f32_16x16x32_bf16 v[36:39], v[112:115], v[108:111], v[36:39]
    ds_read_b64_tr_b16 v[138:139], v150 offset:11776
    v_mfma_f32_16x16x32_bf16 v[40:43], v[116:119], v[104:107], v[40:43]
    ds_read_b64_tr_b16 v[140:141], v151 offset:10528
    v_mfma_f32_16x16x32_bf16 v[44:47], v[116:119], v[108:111], v[44:47]
    ds_read_b64_tr_b16 v[142:143], v151 offset:11808
    s_waitcnt lgkmcnt(8)
    v_mfma_f32_16x16x32_bf16 v[48:51], v[120:123], v[104:107], v[48:51]
    v_mfma_f32_16x16x32_bf16 v[52:55], v[120:123], v[108:111], v[52:55]
    v_mfma_f32_16x16x32_bf16 v[56:59], v[124:127], v[104:107], v[56:59]
    v_mfma_f32_16x16x32_bf16 v[60:63], v[124:127], v[108:111], v[60:63]
    s_waitcnt lgkmcnt(4)
    v_mfma_f32_16x16x32_bf16 v[64:67], v[128:131], v[104:107], v[64:67]
    v_cvt_pk_bf16_f32 v152, v32, v33
    v_cvt_pk_bf16_f32 v153, v34, v35
    v_mfma_f32_16x16x32_bf16 v[68:71], v[128:131], v[108:111], v[68:71]
    v_cvt_pk_bf16_f32 v154, v36, v37
    v_cvt_pk_bf16_f32 v155, v38, v39
    v_mfma_f32_16x16x32_bf16 v[72:75], v[132:135], v[104:107], v[72:75]
    s_nop 0
    v_permlane16_swap_b32 v152, v154
    v_mfma_f32_16x16x32_bf16 v[76:79], v[132:135], v[108:111], v[76:79]
    v_permlane16_swap_b32 v153, v155
    ds_write_b128 v188, v[152:155] offset:0
    s_waitcnt lgkmcnt(2)
    v_mfma_f32_16x16x32_bf16 v[80:83], v[136:139], v[104:107], v[80:83]
    ds_read_b64_tr_b16 v[164:165], v189 offset:0
    ds_read_b64_tr_b16 v[166:167], v189 offset:320
    v_cvt_pk_bf16_f32 v156, v40, v41
    v_cvt_pk_bf16_f32 v157, v42, v43
    v_mfma_f32_16x16x32_bf16 v[84:87], v[136:139], v[108:111], v[84:87]
    ds_read_b64_tr_b16 v[168:169], v189 offset:1280
    ds_read_b64_tr_b16 v[170:171], v189 offset:1600
    v_cvt_pk_bf16_f32 v158, v44, v45
    v_cvt_pk_bf16_f32 v159, v46, v47
    s_waitcnt lgkmcnt(0)
    v_mfma_f32_16x16x32_bf16 v[88:91], v[140:143], v[104:107], v[88:91]
    s_nop 0
    v_permlane16_swap_b32 v156, v158
    v_mfma_f32_16x16x32_bf16 v[92:95], v[140:143], v[108:111], v[92:95]
    v_permlane16_swap_b32 v157, v159
    ds_write_b128 v188, v[156:159] offset:1024
    ds_read_b64_tr_b16 v[172:173], v189 offset:2560
    ds_read_b64_tr_b16 v[174:175], v189 offset:2880
    ds_read_b64_tr_b16 v[176:177], v189 offset:64
    ds_read_b64_tr_b16 v[178:179], v189 offset:384
    ds_read_b64_tr_b16 v[180:181], v189 offset:1344
    ds_read_b64_tr_b16 v[182:183], v189 offset:1664
    ds_read_b64_tr_b16 v[184:185], v189 offset:2624
    ds_read_b64_tr_b16 v[186:187], v189 offset:2944
    v_cvt_pk_bf16_f32 v144, v16, v17
    v_cvt_pk_bf16_f32 v145, v18, v19
    v_cvt_pk_bf16_f32 v146, v20, v21
    v_cvt_pk_bf16_f32 v147, v22, v23
    s_nop 0
    v_permlane16_swap_b32 v144, v146
    v_permlane16_swap_b32 v145, v147
    v_cvt_pk_bf16_f32 v148, v24, v25
    v_cvt_pk_bf16_f32 v149, v26, v27
    v_cvt_pk_bf16_f32 v150, v28, v29
    v_cvt_pk_bf16_f32 v151, v30, v31
    s_nop 0
    v_permlane16_swap_b32 v148, v150
    v_permlane16_swap_b32 v149, v151
    v_cvt_pk_bf16_f32 v160, v48, v49
    v_cvt_pk_bf16_f32 v161, v50, v51
    v_cvt_pk_bf16_f32 v162, v52, v53
    v_cvt_pk_bf16_f32 v163, v54, v55
    s_nop 0
    v_permlane16_swap_b32 v160, v162
    v_permlane16_swap_b32 v161, v163
    ds_write_b128 v188, v[160:163] offset:2048
    s_waitcnt lgkmcnt(0)
L_PHIK:
    s_barrier
    s_cmp_eq_u32 s62, 0
    s_cbranch_scc1 NOHAND_6
    ds_read_b128 v[144:147], v188 offset:0
    ds_read_b128 v[148:151], v188 offset:1024
    ds_read_b128 v[152:155], v188 offset:2048
    s_waitcnt lgkmcnt(0)
NOHAND_6:
    v_mfma_f32_32x32x16_bf16 v[16:31], v[164:167], v[144:147], 0
    v_mfma_f32_32x32x16_bf16 v[16:31], v[168:171], v[148:151], v[16:31]
    v_mfma_f32_32x32x16_bf16 v[16:31], v[172:175], v[152:155], v[16:31]
    v_mfma_f32_32x32x16_bf16 v[32:47], v[176:179], v[144:147], 0
    v_mfma_f32_32x32x16_bf16 v[32:47], v[180:183], v[148:151], v[32:47]
    v_mfma_f32_32x32x16_bf16 v[32:47], v[184:187], v[152:155], v[32:47]
    s_cmp_eq_u32 s62, 0
    s_cbranch_scc0 NOV_7
    v_cvt_pk_bf16_f32 v120, v56, v57
    v_cvt_pk_bf16_f32 v121, v58, v59
    ds_write_b64 v195, v[120:121] offset:0
    v_cvt_pk_bf16_f32 v122, v60, v61
    v_cvt_pk_bf16_f32 v123, v62, v63
    ds_write_b64 v195, v[122:123] offset:2688
    v_cvt_pk_bf16_f32 v124, v64, v65
    v_cvt_pk_bf16_f32 v125, v66, v67
    ds_write_b64 v195, v[124:125] offset:32
    v_cvt_pk_bf16_f32 v126, v68, v69
    v_cvt_pk_bf16_f32 v127, v70, v71
    ds_write_b64 v195, v[126:127] offset:2720
    v_cvt_pk_bf16_f32 v128, v72, v73
    v_cvt_pk_bf16_f32 v129, v74, v75
    ds_write_b64 v195, v[128:129] offset:64
    v_cvt_pk_bf16_f32 v130, v76, v77
    v_cvt_pk_bf16_f32 v131, v78, v79
    ds_write_b64 v195, v[130:131] offset:2752
    v_cvt_pk_bf16_f32 v132, v80, v81
    v_cvt_pk_bf16_f32 v133, v82, v83
    ds_write_b64 v195, v[132:133] offset:96
    v_cvt_pk_bf16_f32 v134, v84, v85
    v_cvt_pk_bf16_f32 v135, v86, v87
    ds_write_b64 v195, v[134:135] offset:2784
    v_cvt_pk_bf16_f32 v136, v88, v89
    v_cvt_pk_bf16_f32 v137, v90, v91
    ds_write_b64 v195, v[136:137] offset:128
    v_cvt_pk_bf16_f32 v138, v92, v93
    v_cvt_pk_bf16_f32 v139, v94, v95
    ds_write_b64 v195, v[138:139] offset:2816
    v_mov_b32 v140, 0x3f80
    v_mov_b32 v141, 0
    ds_write_b64 v196, v[140:141] offset:160
    s_waitcnt lgkmcnt(0)
NOV_7:
    s_nop 6
    v_max3_f32 v236, v16, v17, v18
    v_min3_f32 v237, v16, v17, v18
    v_max3_f32 v236, v236, v19, v20
    v_min3_f32 v237, v237, v19, v20
    v_max3_f32 v236, v236, v21, v22
    v_min3_f32 v237, v237, v21, v22
    v_max3_f32 v236, v236, v23, v24
    v_min3_f32 v237, v237, v23, v24
    v_max3_f32 v236, v236, v25, v26
    v_min3_f32 v237, v237, v25, v26
    v_max3_f32 v236, v236, v27, v28
    v_min3_f32 v237, v237, v27, v28
    v_max3_f32 v236, v236, v29, v30
    v_min3_f32 v237, v237, v29, v30
    v_max3_f32 v236, v236, v31, v32
    v_min3_f32 v237, v237, v31, v32
    v_max3_f32 v236, v236, v33, v34
    v_min3_f32 v237, v237, v33, v34
    s_mov_b32 s66, 0x3fb8aa3b
    v_max_f32 v236, v236, v35
    v_min_f32 v237, v237, v35
    v_mul_f32 v236, s66, v236
    v_mul_f32 v237, s66, v237
    v_mov_b32 v242, s66
    v_mov_b32 v243, s66
    v_pk_fma_f32 v[96:97], v[16:17], v[242:243], v[236:237] op_sel_hi:[1,1,0] neg_lo:[0,0,1] neg_hi:[0,0,1]
    v_pk_fma_f32 v[120:121], v[16:17], v[242:243], v[236:237] op_sel:[0,0,1] op_sel_hi:[1,1,1] neg_lo:[1,0,0] neg_hi:[1,0,0]
    v_pk_fma_f32 v[98:99], v[18:19], v[242:243], v[236:237] op_sel_hi:[1,1,0] neg_lo:[0,0,1] neg_hi:[0,0,1]
    v_pk_fma_f32 v[122:123], v[18:19], v[242:243], v[236:237] op_sel:[0,0,1] op_sel_hi:[1,1,1] neg_lo:[1,0,0] neg_hi:[1,0,0]
    v_pk_fma_f32 v[100:101], v[20:21], v[242:243], v[236:237] op_sel_hi:[1,1,0] neg_lo:[0,0,1] neg_hi:[0,0,1]
    v_pk_fma_f32 v[124:125], v[20:21], v[242:243], v[236:237] op_sel:[0,0,1] op_sel_hi:[1,1,1] neg_lo:[1,0,0] neg_hi:[1,0,0]
    v_pk_fma_f32 v[102:103], v[22:23], v[242:243], v[236:237] op_sel_hi:[1,1,0] neg_lo:[0,0,1] neg_hi:[0,0,1]
    v_pk_fma_f32 v[126:127], v[22:23], v[242:243], v[236:237] op_sel:[0,0,1] op_sel_hi:[1,1,1] neg_lo:[1,0,0] neg_hi:[1,0,0]
    v_pk_fma_f32 v[104:105], v[24:25], v[242:243], v[236:237] op_sel_hi:[1,1,0] neg_lo:[0,0,1] neg_hi:[0,0,1]
    v_pk_fma_f32 v[128:129], v[24:25], v[242:243], v[236:237] op_sel:[0,0,1] op_sel_hi:[1,1,1] neg_lo:[1,0,0] neg_hi:[1,0,0]
    v_pk_fma_f32 v[106:107], v[26:27], v[242:243], v[236:237] op_sel_hi:[1,1,0] neg_lo:[0,0,1] neg_hi:[0,0,1]
    v_pk_fma_f32 v[130:131], v[26:27], v[242:243], v[236:237] op_sel:[0,0,1] op_sel_hi:[1,1,1] neg_lo:[1,0,0] neg_hi:[1,0,0]
    v_pk_fma_f32 v[108:109], v[28:29], v[242:243], v[236:237] op_sel_hi:[1,1,0] neg_lo:[0,0,1] neg_hi:[0,0,1]
    v_pk_fma_f32 v[132:133], v[28:29], v[242:243], v[236:237] op_sel:[0,0,1] op_sel_hi:[1,1,1] neg_lo:[1,0,0] neg_hi:[1,0,0]
    v_pk_fma_f32 v[110:111], v[30:31], v[242:243], v[236:237] op_sel_hi:[1,1,0] neg_lo:[0,0,1] neg_hi:[0,0,1]
    v_pk_fma_f32 v[134:135], v[30:31], v[242:243], v[236:237] op_sel:[0,0,1] op_sel_hi:[1,1,1] neg_lo:[1,0,0] neg_hi:[1,0,0]
    v_pk_fma_f32 v[112:113], v[32:33], v[242:243], v[236:237] op_sel_hi:[1,1,0] neg_lo:[0,0,1] neg_hi:[0,0,1]
    v_pk_fma_f32 v[136:137], v[32:33], v[242:243], v[236:237] op_sel:[0,0,1] op_sel_hi:[1,1,1] neg_lo:[1,0,0] neg_hi:[1,0,0]
    v_pk_fma_f32 v[114:115], v[34:35], v[242:243], v[236:237] op_sel_hi:[1,1,0] neg_lo:[0,0,1] neg_hi:[0,0,1]
    v_pk_fma_f32 v[138:139], v[34:35], v[242:243], v[236:237] op_sel:[0,0,1] op_sel_hi:[1,1,1] neg_lo:[1,0,0] neg_hi:[1,0,0]
    v_exp_f32 v96, v96
    v_exp_f32 v120, v120
    v_exp_f32 v97, v97
    v_exp_f32 v121, v121
    v_exp_f32 v98, v98
    v_exp_f32 v122, v122
    v_exp_f32 v99, v99
    v_exp_f32 v123, v123
    v_exp_f32 v100, v100
    v_exp_f32 v124, v124
    v_exp_f32 v101, v101
    v_exp_f32 v125, v125
    v_pk_add_f32 v[238:239], v[96:97], v[98:99]
    v_pk_add_f32 v[240:241], v[120:121], v[122:123]
    v_exp_f32 v102, v102
    v_exp_f32 v126, v126
    v_exp_f32 v103, v103
    v_exp_f32 v127, v127
    v_pk_add_f32 v[238:239], v[238:239], v[100:101]
    v_pk_add_f32 v[240:241], v[240:241], v[124:125]
    v_exp_f32 v104, v104
    v_exp_f32 v128, v128
    v_exp_f32 v105, v105
    v_exp_f32 v129, v129
    v_pk_add_f32 v[238:239], v[238:239], v[102:103]
    v_pk_add_f32 v[240:241], v[240:241], v[126:127]
    v_exp_f32 v106, v106
    v_exp_f32 v130, v130
    v_exp_f32 v107, v107
    v_exp_f32 v131, v131
    v_pk_add_f32 v[238:239], v[238:239], v[104:105]
    v_pk_add_f32 v[240:241], v[240:241], v[128:129]
    v_exp_f32 v108, v108
    v_exp_f32 v132, v132
    v_exp_f32 v109, v109
    v_exp_f32 v133, v133
    v_pk_add_f32 v[238:239], v[238:239], v[106:107]
    v_pk_add_f32 v[240:241], v[240:241], v[130:131]
    v_exp_f32 v110, v110
    v_exp_f32 v134, v134
    v_exp_f32 v111, v111
    v_exp_f32 v135, v135
    v_pk_add_f32 v[238:239], v[238:239], v[108:109]
    v_pk_add_f32 v[240:241], v[240:241], v[132:133]
    v_exp_f32 v112, v112
    v_exp_f32 v136, v136
    v_exp_f32 v113, v113
    v_exp_f32 v137, v137
    v_pk_add_f32 v[238:239], v[238:239], v[110:111]
    v_pk_add_f32 v[240:241], v[240:241], v[134:135]
    v_exp_f32 v114, v114
    v_exp_f32 v138, v138
    v_exp_f32 v115, v115
    v_exp_f32 v139, v139
    v_pk_add_f32 v[238:239], v[238:239], v[112:113]
    v_pk_add_f32 v[240:241], v[240:241], v[136:137]
    s_nop 0
    v_pk_add_f32 v[238:239], v[238:239], v[114:115]
    v_pk_add_f32 v[240:241], v[240:241], v[138:139]
    v_add_f32 v238, v238, v239
    v_add_f32 v240, v240, v241
    v_rcp_f32 v238, v238
    v_rcp_f32 v240, v240
    s_nop 0
    v_pk_mul_f32 v[96:97], v[96:97], v[238:239] op_sel_hi:[1,0]
    v_pk_mul_f32 v[98:99], v[98:99], v[238:239] op_sel_hi:[1,0]
    v_cvt_pk_bf16_f32 v216, v96, v97
    v_cvt_pk_bf16_f32 v217, v98, v99
    v_pk_mul_f32 v[100:101], v[100:101], v[238:239] op_sel_hi:[1,0]
    v_pk_mul_f32 v[102:103], v[102:103], v[238:239] op_sel_hi:[1,0]
    v_cvt_pk_bf16_f32 v218, v100, v101
    v_cvt_pk_bf16_f32 v219, v102, v103
    ds_write_b128 v190, v[216:219] offset:0
    v_pk_mul_f32 v[104:105], v[104:105], v[238:239] op_sel_hi:[1,0]
    v_pk_mul_f32 v[106:107], v[106:107], v[238:239] op_sel_hi:[1,0]
    v_cvt_pk_bf16_f32 v220, v104, v105
    v_cvt_pk_bf16_f32 v221, v106, v107
    v_pk_mul_f32 v[108:109], v[108:109], v[238:239] op_sel_hi:[1,0]
    v_pk_mul_f32 v[110:111], v[110:111], v[238:239] op_sel_hi:[1,0]
    v_cvt_pk_bf16_f32 v222, v108, v109
    v_cvt_pk_bf16_f32 v223, v110, v111
    ds_write_b128 v190, v[220:223] offset:16
    v_pk_mul_f32 v[112:113], v[112:113], v[238:239] op_sel_hi:[1,0]
    v_pk_mul_f32 v[114:115], v[114:115], v[238:239] op_sel_hi:[1,0]
    v_cvt_pk_bf16_f32 v224, v112, v113
    v_cvt_pk_bf16_f32 v225, v114, v115
    v_pk_mul_f32 v[120:121], v[120:121], v[240:241] op_sel_hi:[1,0]
    v_pk_mul_f32 v[122:123], v[122:123], v[240:241] op_sel_hi:[1,0]
    v_cvt_pk_bf16_f32 v226, v120, v121
    v_cvt_pk_bf16_f32 v227, v122, v123
    ds_write_b128 v190, v[224:227] offset:32
    v_pk_mul_f32 v[124:125], v[124:125], v[240:241] op_sel_hi:[1,0]
    v_pk_mul_f32 v[126:127], v[126:127], v[240:241] op_sel_hi:[1,0]
    v_cvt_pk_bf16_f32 v228, v124, v125
    v_cvt_pk_bf16_f32 v229, v126, v127
    v_pk_mul_f32 v[128:129], v[128:129], v[240:241] op_sel_hi:[1,0]
    v_pk_mul_f32 v[130:131], v[130:131], v[240:241] op_sel_hi:[1,0]
    v_cvt_pk_bf16_f32 v230, v128, v129
    v_cvt_pk_bf16_f32 v231, v130, v131
    ds_write_b128 v190, v[228:231] offset:48
    v_pk_mul_f32 v[132:133], v[132:133], v[240:241] op_sel_hi:[1,0]
    v_pk_mul_f32 v[134:135], v[134:135], v[240:241] op_sel_hi:[1,0]
    v_cvt_pk_bf16_f32 v232, v132, v133
    v_cvt_pk_bf16_f32 v233, v134, v135
    v_pk_mul_f32 v[136:137], v[136:137], v[240:241] op_sel_hi:[1,0]
    v_pk_mul_f32 v[138:139], v[138:139], v[240:241] op_sel_hi:[1,0]
    v_cvt_pk_bf16_f32 v234, v136, v137
    v_cvt_pk_bf16_f32 v235, v138, v139
    ds_write_b128 v190, v[232:235] offset:64
    s_cmp_eq_u32 s40, 0
    s_cbranch_scc0 NOB1_8
    s_waitcnt vmcnt(0)
    v_readfirstlane_b32 s61, v197
    s_nop 0
    s_cmp_ge_u32 s61, 80
    s_cbranch_scc1 NOB1_8
    v_mov_b32 v2, 0
    s_mov_b32 s63, 131072
    s_mov_b64 exec, 1
POLL_9:
    v_mov_b32 v3, 0
    buffer_atomic_add v3, v2, s[36:39], s55 offen sc0
    s_waitcnt vmcnt(0)
    v_readfirstlane_b32 s61, v3
    s_sub_u32 s63, s63, 1
    s_cbranch_scc1 POLLD_10
    s_cmp_ge_u32 s61, 80
    s_cbranch_scc1 POLLD_10
    s_sleep 2
    s_branch POLL_9
POLLD_10:
    s_mov_b64 exec, -1
NOB1_8:
    s_waitcnt lgkmcnt(0)
    s_barrier
    ds_read_b64_tr_b16 v[16:17], v191 offset:0
    ds_read_b64_tr_b16 v[18:19], v191 offset:672
    ds_read_b64_tr_b16 v[48:49], v192 offset:0
    ds_read_b64_tr_b16 v[50:51], v192 offset:1344
    ds_read_b64_tr_b16 v[20:21], v191 offset:2688
    ds_read_b64_tr_b16 v[22:23], v191 offset:3360
    ds_read_b64_tr_b16 v[52:53], v192 offset:5376
    ds_read_b64_tr_b16 v[54:55], v192 offset:6720
    ds_read_b64_tr_b16 v[24:25], v191 offset:5376
    ds_read_b64_tr_b16 v[26:27], v191 offset:6048
    ds_read_b64_tr_b16 v[56:57], v192 offset:10752
    ds_read_b64_tr_b16 v[58:59], v192 offset:12096
    s_waitcnt lgkmcnt(8)
    v_mfma_f32_32x32x16_bf16 v[80:95], v[16:19], v[48:51], 0
    ds_read_b64_tr_b16 v[28:29], v191 offset:8064
    ds_read_b64_tr_b16 v[30:31], v191 offset:8736
    ds_read_b64_tr_b16 v[60:61], v192 offset:16128
    ds_read_b64_tr_b16 v[62:63], v192 offset:17472
    s_waitcnt lgkmcnt(8)
    v_mfma_f32_32x32x16_bf16 v[80:95], v[20:23], v[52:55], v[80:95]
    ds_read_b64_tr_b16 v[32:33], v191 offset:10752
    ds_read_b64_tr_b16 v[34:35], v191 offset:11424
    ds_read_b64_tr_b16 v[64:65], v192 offset:21504
    ds_read_b64_tr_b16 v[66:67], v192 offset:22848
    s_waitcnt lgkmcnt(8)
    v_mfma_f32_32x32x16_bf16 v[80:95], v[24:27], v[56:59], v[80:95]
    ds_read_b64_tr_b16 v[36:37], v191 offset:13440
    ds_read_b64_tr_b16 v[38:39], v191 offset:14112
    ds_read_b64_tr_b16 v[68:69], v192 offset:26880
    ds_read_b64_tr_b16 v[70:71], v192 offset:28224
    s_waitcnt lgkmcnt(8)
    v_mfma_f32_32x32x16_bf16 v[80:95], v[28:31], v[60:63], v[80:95]
    ds_read_b64_tr_b16 v[40:41], v191 offset:16128
    ds_read_b64_tr_b16 v[42:43], v191 offset:16800
    ds_read_b64_tr_b16 v[72:73], v192 offset:32256
    ds_read_b64_tr_b16 v[74:75], v192 offset:33600
    s_waitcnt lgkmcnt(8)
    v_mfma_f32_32x32x16_bf16 v[80:95], v[32:35], v[64:67], v[80:95]
    ds_read_b64_tr_b16 v[44:45], v191 offset:18816
    ds_read_b64_tr_b16 v[46:47], v191 offset:19488
    ds_read_b64_tr_b16 v[76:77], v192 offset:37632
    ds_read_b64_tr_b16 v[78:79], v192 offset:38976
    s_waitcnt lgkmcnt(8)
    v_mfma_f32_32x32x16_bf16 v[80:95], v[36:39], v[68:71], v[80:95]
    s_waitcnt lgkmcnt(4)
    v_mfma_f32_32x32x16_bf16 v[80:95], v[40:43], v[72:75], v[80:95]
    s_waitcnt lgkmcnt(0)
    v_mfma_f32_32x32x16_bf16 v[80:95], v[44:47], v[76:79], v[80:95]
    s_nop 7
    s_nop 3
    v_cvt_pk_bf16_f32 v96, v80, v81
    buffer_atomic_pk_add_bf16 v96, v193, s[36:39], s52 offen offset:0
    v_cvt_pk_bf16_f32 v97, v82, v83
    buffer_atomic_pk_add_bf16 v97, v193, s[36:39], s52 offen offset:192
    v_cvt_pk_bf16_f32 v98, v84, v85
    buffer_atomic_pk_add_bf16 v98, v193, s[36:39], s52 offen offset:768
    v_cvt_pk_bf16_f32 v99, v86, v87
    buffer_atomic_pk_add_bf16 v99, v193, s[36:39], s52 offen offset:960
    v_cvt_pk_bf16_f32 v100, v88, v89
    buffer_atomic_pk_add_bf16 v100, v193, s[36:39], s52 offen offset:1536
    v_cvt_pk_bf16_f32 v101, v90, v91
    buffer_atomic_pk_add_bf16 v101, v194, s[36:39], s52 offen offset:1728
    s_lshl_b32 s66, s44, 3
    s_lshr_b32 s67, s43, 1
    s_add_u32 s66, s66, s67
    s_and_b32 s67, s43, 1
    s_lshl_b32 s67, s67, 3
    s_cmp_eq_u32 s2, 0
    s_cselect_b32 s70, 0, 1.0
    s_cmp_eq_u32 s2, 8
    s_cselect_b32 s46, 64, s66
    s_cselect_b32 s67, 0, s67
    s_cselect_b32 s68, 64, 0
    s_cselect_b32 s69, 0, 1.0
    s_cselect_b32 s71, 0, 0x3e800000
    s_cmp_ge_u32 s40, 4
    s_cbranch_scc1 TMK_16
    s_cmp_ge_u32 s40, 2
    s_cbranch_scc1 TMK_14
    s_cmp_ge_u32 s40, 1
    s_cbranch_scc1 TMK_13
    v_lshrrev_b32 v40, 5, v1
    v_bfe_u32 v5, v1, 2, 1
    v_mul_u32_u24 v5, 10, v5
    v_bfe_u32 v6, v1, 1, 1
    v_add_u32 v5, v5, v6
    v_bfe_u32 v6, v1, 3, 2
    v_lshl_add_u32 v6, v6, 1, v5
    v_cvt_f32_u32 v6, v6
    v_mul_f32 v41, 0x3d4ccccd, v6
    v_and_b32 v5, 1, v1
    v_cvt_f32_u32 v5, v5
    v_mul_f32 v42, 0x3e800000, v5
    v_cmp_eq_u32 vcc, 0, v40
    v_mov_b32 v12, 0x41000000
    v_mov_b32 v13, 0x00000000
    v_cndmask_b32 v12, v12, v13, vcc
    v_mov_b32 v13, 0x00000000
    v_mov_b32 v10, 0x00000000
    v_cndmask_b32 v13, v13, v10, vcc
    v_sub_f32 v13, v42, v13
    v_fma_f32 v10, v41, v12, v13
    v_add_f32 v11, v10, v41
    v_cos_f32 v12, v10
    v_cos_f32 v13, v11
    v_add_f32 v10, v11, v41
    v_cvt_pk_bf16_f32 v16, v12, v13
    v_add_f32 v11, v10, v41
    v_cos_f32 v12, v10
    v_cos_f32 v13, v11
    s_nop 0
    v_cvt_pk_bf16_f32 v17, v12, v13
    v_cmp_eq_u32 vcc, 0, v40
    v_mov_b32 v12, 0x41400000
    v_mov_b32 v13, 0x40800000
    v_cndmask_b32 v12, v12, v13, vcc
    v_mov_b32 v13, 0x00000000
    v_mov_b32 v10, 0x00000000
    v_cndmask_b32 v13, v13, v10, vcc
    v_sub_f32 v13, v42, v13
    v_fma_f32 v10, v41, v12, v13
    v_add_f32 v11, v10, v41
    v_cos_f32 v12, v10
    v_cos_f32 v13, v11
    v_add_f32 v10, v11, v41
    v_cvt_pk_bf16_f32 v18, v12, v13
    v_add_f32 v11, v10, v41
    v_cos_f32 v12, v10
    v_cos_f32 v13, v11
    s_nop 0
    v_cvt_pk_bf16_f32 v19, v12, v13
    v_cmp_eq_u32 vcc, 0, v40
    v_mov_b32 v12, 0x40800000
    v_mov_b32 v13, 0x41800000
    v_cndmask_b32 v12, v12, v13, vcc
    v_mov_b32 v13, 0x3e800000
    v_mov_b32 v10, 0x00000000
    v_cndmask_b32 v13, v13, v10, vcc
    v_sub_f32 v13, v42, v13
    v_fma_f32 v10, v41, v12, v13
    v_add_f32 v11, v10, v41
    v_cos_f32 v12, v10
    v_cos_f32 v13, v11
    v_add_f32 v10, v11, v41
    v_cvt_pk_bf16_f32 v20, v12, v13
    v_add_f32 v11, v10, v41
    v_cos_f32 v12, v10
    v_cos_f32 v13, v11
    s_nop 0
    v_cvt_pk_bf16_f32 v21, v12, v13
    v_cmp_eq_u32 vcc, 0, v40
    v_mov_b32 v12, 0x41000000
    v_mov_b32 v13, 0x00000000
    v_cndmask_b32 v12, v12, v13, vcc
    v_mov_b32 v13, 0x3e800000
    v_mov_b32 v10, 0x3e800000
    v_cndmask_b32 v13, v13, v10, vcc
    v_sub_f32 v13, v42, v13
    v_fma_f32 v10, v41, v12, v13
    v_add_f32 v11, v10, v41
    v_cos_f32 v12, v10
    v_cos_f32 v13, v11
    v_add_f32 v10, v11, v41
    v_cvt_pk_bf16_f32 v22, v12, v13
    v_add_f32 v11, v10, v41
    v_cos_f32 v12, v10
    v_cos_f32 v13, v11
    s_nop 0
    v_cvt_pk_bf16_f32 v23, v12, v13
    s_nop 0
    ds_write_b128 v208, v[16:19] offset:0
    ds_write_b128 v208, v[20:23] offset:1024
    s_branch TMKE_11
TMK_13:
    v_lshrrev_b32 v40, 5, v1
    v_bfe_u32 v5, v1, 2, 1
    v_mul_u32_u24 v5, 10, v5
    v_bfe_u32 v6, v1, 1, 1
    v_add_u32 v5, v5, v6
    v_bfe_u32 v6, v1, 3, 2
    v_lshl_add_u32 v6, v6, 1, v5
    v_cvt_f32_u32 v6, v6
    v_mul_f32 v41, 0x3d4ccccd, v6
    v_and_b32 v5, 1, v1
    v_cvt_f32_u32 v5, v5
    v_mul_f32 v42, 0x3e800000, v5
    v_cmp_eq_u32 vcc, 0, v40
    v_mov_b32 v12, 0x00000000
    v_mov_b32 v13, 0x41400000
    v_cndmask_b32 v12, v12, v13, vcc
    v_mov_b32 v13, 0x3e800000
    v_mov_b32 v10, 0x3e800000
    v_cndmask_b32 v13, v13, v10, vcc
    v_sub_f32 v13, v42, v13
    v_fma_f32 v10, v41, v12, v13
    v_add_f32 v11, v10, v41
    v_cos_f32 v12, v10
    v_cos_f32 v13, v11
    v_add_f32 v10, v11, v41
    v_cvt_pk_bf16_f32 v24, v12, v13
    v_cndmask_b32 v24, 0, v24, vcc
    v_add_f32 v11, v10, v41
    v_cos_f32 v12, v10
    v_cos_f32 v13, v11
    s_nop 0
    v_cvt_pk_bf16_f32 v25, v12, v13
    v_cndmask_b32 v25, 0, v25, vcc
    v_cmp_eq_u32 vcc, 0, v40
    v_mov_b32 v12, 0x40800000
    v_mov_b32 v13, 0x41800000
    v_cndmask_b32 v12, v12, v13, vcc
    v_mov_b32 v13, 0x3e800000
    v_mov_b32 v10, 0x3e800000
    v_cndmask_b32 v13, v13, v10, vcc
    v_sub_f32 v13, v42, v13
    v_fma_f32 v10, v41, v12, v13
    v_add_f32 v11, v10, v41
    v_cos_f32 v12, v10
    v_cos_f32 v13, v11
    v_add_f32 v10, v11, v41
    v_cvt_pk_bf16_f32 v26, v12, v13
    v_cndmask_b32 v26, 0, v26, vcc
    v_add_f32 v11, v10, v41
    v_cos_f32 v12, v10
    v_cos_f32 v13, v11
    s_nop 0
    v_cvt_pk_bf16_f32 v27, v12, v13
    v_cndmask_b32 v27, 0, v27, vcc
    v_lshrrev_b32 v40, 5, v1
    v_bfe_u32 v5, v1, 2, 1
    v_mul_u32_u24 v5, 10, v5
    v_bfe_u32 v6, v1, 1, 1
    v_add_u32 v5, v5, v6
    v_add_u32 v6, 8, v5
    v_cvt_f32_u32 v6, v6
    v_mul_f32 v41, 0x3d4ccccd, v6
    v_and_b32 v5, 1, v1
    v_cvt_f32_u32 v5, v5
    v_mul_f32 v42, 0x3e800000, v5
    v_cmp_eq_u32 vcc, 0, v40
    v_mov_b32 v12, 0x41000000
    v_mov_b32 v13, 0x00000000
    v_cndmask_b32 v12, v12, v13, vcc
    v_mov_b32 v13, 0x00000000
    v_mov_b32 v10, 0x00000000
    v_cndmask_b32 v13, v13, v10, vcc
    v_sub_f32 v13, v42, v13
    v_fma_f32 v10, v41, v12, v13
    v_add_f32 v11, v10, v41
    v_cos_f32 v12, v10
    v_cos_f32 v13, v11
    v_add_f32 v10, v11, v41
    v_cvt_pk_bf16_f32 v16, v12, v13
    v_add_f32 v11, v10, v41
    v_cos_f32 v12, v10
    v_cos_f32 v13, v11
    s_nop 0
    v_cvt_pk_bf16_f32 v17, v12, v13
    v_cmp_eq_u32 vcc, 0, v40
    v_mov_b32 v12, 0x41400000
    v_mov_b32 v13, 0x40800000
    v_cndmask_b32 v12, v12, v13, vcc
    v_mov_b32 v13, 0x00000000
    v_mov_b32 v10, 0x00000000
    v_cndmask_b32 v13, v13, v10, vcc
    v_sub_f32 v13, v42, v13
    v_fma_f32 v10, v41, v12, v13
    v_add_f32 v11, v10, v41
    v_cos_f32 v12, v10
    v_cos_f32 v13, v11
    v_add_f32 v10, v11, v41
    v_cvt_pk_bf16_f32 v18, v12, v13
    v_add_f32 v11, v10, v41
    v_cos_f32 v12, v10
    v_cos_f32 v13, v11
    s_nop 0
    v_cvt_pk_bf16_f32 v19, v12, v13
    s_nop 0
    ds_write_b128 v208, v[24:27] offset:2048
    ds_write_b128 v208, v[16:19] offset:3072
    s_branch TMKE_11
TMK_14:
    s_cmp_ge_u32 s40, 3
    s_cbranch_scc1 TMK_15
    v_lshrrev_b32 v40, 5, v1
    v_bfe_u32 v5, v1, 2, 1
    v_mul_u32_u24 v5, 10, v5
    v_bfe_u32 v6, v1, 1, 1
    v_add_u32 v5, v5, v6
    v_add_u32 v6, 8, v5
    v_cvt_f32_u32 v6, v6
    v_mul_f32 v41, 0x3d4ccccd, v6
    v_and_b32 v5, 1, v1
    v_cvt_f32_u32 v5, v5
    v_mul_f32 v42, 0x3e800000, v5
    v_cmp_eq_u32 vcc, 0, v40
    v_mov_b32 v12, 0x40800000
    v_mov_b32 v13, 0x41800000
    v_cndmask_b32 v12, v12, v13, vcc
    v_mov_b32 v13, 0x3e800000
    v_mov_b32 v10, 0x00000000
    v_cndmask_b32 v13, v13, v10, vcc
    v_sub_f32 v13, v42, v13
    v_fma_f32 v10, v41, v12, v13
    v_add_f32 v11, v10, v41
    v_cos_f32 v12, v10
    v_cos_f32 v13, v11
    v_add_f32 v10, v11, v41
    v_cvt_pk_bf16_f32 v20, v12, v13
    v_add_f32 v11, v10, v41
    v_cos_f32 v12, v10
    v_cos_f32 v13, v11
    s_nop 0
    v_cvt_pk_bf16_f32 v21, v12, v13
    v_cmp_eq_u32 vcc, 0, v40
    v_mov_b32 v12, 0x41000000
    v_mov_b32 v13, 0x00000000
    v_cndmask_b32 v12, v12, v13, vcc
    v_mov_b32 v13, 0x3e800000
    v_mov_b32 v10, 0x3e800000
    v_cndmask_b32 v13, v13, v10, vcc
    v_sub_f32 v13, v42, v13
    v_fma_f32 v10, v41, v12, v13
    v_add_f32 v11, v10, v41
    v_cos_f32 v12, v10
    v_cos_f32 v13, v11
    v_add_f32 v10, v11, v41
    v_cvt_pk_bf16_f32 v22, v12, v13
    v_add_f32 v11, v10, v41
    v_cos_f32 v12, v10
    v_cos_f32 v13, v11
    s_nop 0
    v_cvt_pk_bf16_f32 v23, v12, v13
    v_cmp_eq_u32 vcc, 0, v40
    v_mov_b32 v12, 0x00000000
    v_mov_b32 v13, 0x41400000
    v_cndmask_b32 v12, v12, v13, vcc
    v_mov_b32 v13, 0x3e800000
    v_mov_b32 v10, 0x3e800000
    v_cndmask_b32 v13, v13, v10, vcc
    v_sub_f32 v13, v42, v13
    v_fma_f32 v10, v41, v12, v13
    v_add_f32 v11, v10, v41
    v_cos_f32 v12, v10
    v_cos_f32 v13, v11
    v_add_f32 v10, v11, v41
    v_cvt_pk_bf16_f32 v24, v12, v13
    v_cndmask_b32 v24, 0, v24, vcc
    v_add_f32 v11, v10, v41
    v_cos_f32 v12, v10
    v_cos_f32 v13, v11
    s_nop 0
    v_cvt_pk_bf16_f32 v25, v12, v13
    v_cndmask_b32 v25, 0, v25, vcc
    v_cmp_eq_u32 vcc, 0, v40
    v_mov_b32 v12, 0x40800000
    v_mov_b32 v13, 0x41800000
    v_cndmask_b32 v12, v12, v13, vcc
    v_mov_b32 v13, 0x3e800000
    v_mov_b32 v10, 0x3e800000
    v_cndmask_b32 v13, v13, v10, vcc
    v_sub_f32 v13, v42, v13
    v_fma_f32 v10, v41, v12, v13
    v_add_f32 v11, v10, v41
    v_cos_f32 v12, v10
    v_cos_f32 v13, v11
    v_add_f32 v10, v11, v41
    v_cvt_pk_bf16_f32 v26, v12, v13
    v_cndmask_b32 v26, 0, v26, vcc
    v_add_f32 v11, v10, v41
    v_cos_f32 v12, v10
    v_cos_f32 v13, v11
    s_nop 0
    v_cvt_pk_bf16_f32 v27, v12, v13
    v_cndmask_b32 v27, 0, v27, vcc
    s_nop 0
    ds_write_b128 v208, v[20:23] offset:4096
    ds_write_b128 v208, v[24:27] offset:5120
    s_branch TMKE_11
TMK_15:
    v_lshrrev_b32 v40, 5, v1
    v_and_b32 v5, 1, v1
    v_cvt_f32_u32 v5, v5
    v_mul_f32 v42, 0x3e800000, v5
    v_bfe_u32 v3, v1, 1, 3
    v_add_u32 v3, s67, v3
    v_lshl_add_u32 v3, v3, 7, s68
    v_cvt_f32_u32 v3, v3
    v_mul_f32 v43, 0x3a000000, v3
    v_lshrrev_b32 v6, 4, v1
    v_lshlrev_b32 v6, 2, v6
    v_cvt_f32_u32 v6, v6
    v_fma_f32 v44, v43, v6, v42
    s_mov_b32 s59, 0x00000000
    v_fma_f32 v10, v43, s59, v44
    v_subrev_f32 v11, s71, v10
    v_cos_f32 v10, v10
    v_cos_f32 v11, v11
    s_nop 0
    v_mul_f32 v10, s69, v10
    v_mul_f32 v11, s70, v11
    v_cvt_pk_bf16_f32 v28, v10, v11
    v_xor_b32 v32, 0, v28
    s_mov_b32 s59, 0x3f800000
    v_fma_f32 v10, v43, s59, v44
    v_subrev_f32 v11, s71, v10
    v_cos_f32 v10, v10
    v_cos_f32 v11, v11
    s_nop 0
    v_mul_f32 v10, s69, v10
    v_mul_f32 v11, s70, v11
    v_cvt_pk_bf16_f32 v29, v10, v11
    v_xor_b32 v33, 0x80008000, v29
    s_mov_b32 s59, 0x40000000
    v_fma_f32 v10, v43, s59, v44
    v_subrev_f32 v11, s71, v10
    v_cos_f32 v10, v10
    v_cos_f32 v11, v11
    s_nop 0
    v_mul_f32 v10, s69, v10
    v_mul_f32 v11, s70, v11
    v_cvt_pk_bf16_f32 v30, v10, v11
    v_xor_b32 v34, 0, v30
    s_mov_b32 s59, 0x40400000
    v_fma_f32 v10, v43, s59, v44
    v_subrev_f32 v11, s71, v10
    v_cos_f32 v10, v10
    v_cos_f32 v11, v11
    s_nop 0
    v_mul_f32 v10, s69, v10
    v_mul_f32 v11, s70, v11
    v_cvt_pk_bf16_f32 v31, v10, v11
    v_xor_b32 v35, 0x80008000, v31
    s_nop 0
    ds_write_b128 v208, v[28:31] offset:6144
    ds_write_b128 v208, v[32:35] offset:7168
    s_branch TMKE_11
TMK_16:
    s_cmp_ge_u32 s40, 6
    s_cbranch_scc1 TMK_18
    s_cmp_ge_u32 s40, 5
    s_cbranch_scc1 TMK_17
    v_and_b32 v2, 31, v1
    v_lshrrev_b32 v40, 5, v1
    v_cvt_f32_u32 v5, v2
    v_mul_f32 v41, 0x3d000000, v5
    v_lshlrev_b32 v6, 2, v40
    v_cvt_f32_u32 v6, v6
    v_mul_f32 v42, v41, v6
    s_mov_b32 s59, 0x00000000
    v_fma_f32 v10, v41, s59, v42
    v_cos_f32 v11, v10
    v_sin_f32 v12, v10
    s_nop 0
    v_cvt_pk_bf16_f32 v16, v11, v12
    s_mov_b32 s59, 0x3f800000
    v_fma_f32 v10, v41, s59, v42
    v_cos_f32 v11, v10
    v_sin_f32 v12, v10
    s_nop 0
    v_cvt_pk_bf16_f32 v17, v11, v12
    s_mov_b32 s59, 0x40000000
    v_fma_f32 v10, v41, s59, v42
    v_cos_f32 v11, v10
    v_sin_f32 v12, v10
    s_nop 0
    v_cvt_pk_bf16_f32 v18, v11, v12
    s_mov_b32 s59, 0x40400000
    v_fma_f32 v10, v41, s59, v42
    v_cos_f32 v11, v10
    v_sin_f32 v12, v10
    s_nop 0
    v_cvt_pk_bf16_f32 v19, v11, v12
    s_mov_b32 s59, 0x41000000
    v_fma_f32 v10, v41, s59, v42
    v_cos_f32 v11, v10
    v_sin_f32 v12, v10
    s_nop 0
    v_cvt_pk_bf16_f32 v20, v11, v12
    s_mov_b32 s59, 0x41100000
    v_fma_f32 v10, v41, s59, v42
    v_cos_f32 v11, v10
    v_sin_f32 v12, v10
    s_nop 0
    v_cvt_pk_bf16_f32 v21, v11, v12
    s_mov_b32 s59, 0x41200000
    v_fma_f32 v10, v41, s59, v42
    v_cos_f32 v11, v10
    v_sin_f32 v12, v10
    s_nop 0
    v_cvt_pk_bf16_f32 v22, v11, v12
    s_mov_b32 s59, 0x41300000
    v_fma_f32 v10, v41, s59, v42
    v_cos_f32 v11, v10
    v_sin_f32 v12, v10
    s_nop 0
    v_cvt_pk_bf16_f32 v23, v11, v12
    s_nop 0
    ds_write_b128 v198, v[16:19] offset:0
    ds_write_b128 v198, v[20:23] offset:1024
    s_branch TMKE_11
TMK_17:
    v_and_b32 v2, 31, v1
    v_lshrrev_b32 v40, 5, v1
    v_cvt_f32_u32 v5, v2
    v_mul_f32 v41, 0x3d000000, v5
    v_lshlrev_b32 v6, 2, v40
    v_cvt_f32_u32 v6, v6
    v_mul_f32 v42, v41, v6
    s_mov_b32 s59, 0x41800000
    v_fma_f32 v10, v41, s59, v42
    v_cos_f32 v11, v10
    v_sin_f32 v12, v10
    s_nop 0
    v_cvt_pk_bf16_f32 v24, v11, v12
    s_mov_b32 s59, 0x41880000
    v_fma_f32 v10, v41, s59, v42
    v_cos_f32 v11, v10
    v_sin_f32 v12, v10
    s_nop 0
    v_cvt_pk_bf16_f32 v25, v11, v12
    s_mov_b32 s59, 0x41900000
    v_fma_f32 v10, v41, s59, v42
    v_cos_f32 v11, v10
    v_sin_f32 v12, v10
    s_nop 0
    v_cvt_pk_bf16_f32 v26, v11, v12
    s_mov_b32 s59, 0x41980000
    v_fma_f32 v10, v41, s59, v42
    v_cos_f32 v11, v10
    v_sin_f32 v12, v10
    s_nop 0
    v_cvt_pk_bf16_f32 v27, v11, v12
    s_mov_b32 s59, 0x41c00000
    v_fma_f32 v10, v41, s59, v42
    v_cos_f32 v11, v10
    v_sin_f32 v12, v10
    s_nop 0
    v_cvt_pk_bf16_f32 v28, v11, v12
    s_mov_b32 s59, 0x41c80000
    v_fma_f32 v10, v41, s59, v42
    v_cos_f32 v11, v10
    v_sin_f32 v12, v10
    s_nop 0
    v_cvt_pk_bf16_f32 v29, v11, v12
    s_mov_b32 s59, 0x41d00000
    v_fma_f32 v10, v41, s59, v42
    v_cos_f32 v11, v10
    v_sin_f32 v12, v10
    s_nop 0
    v_cvt_pk_bf16_f32 v30, v11, v12
    s_mov_b32 s59, 0x41d80000
    v_fma_f32 v10, v41, s59, v42
    v_cos_f32 v11, v10
    v_sin_f32 v12, v10
    s_nop 0
    v_cvt_pk_bf16_f32 v31, v11, v12
    s_nop 0
    ds_write_b128 v198, v[24:27] offset:2048
    ds_write_b128 v198, v[28:31] offset:3072
    s_branch TMKE_11
TMK_18:
    s_cmp_ge_u32 s40, 7
    s_cbranch_scc1 TMK_19
    v_and_b32 v2, 31, v1
    v_lshrrev_b32 v40, 5, v1
    v_cvt_f32_u32 v5, v2
    v_mul_f32 v41, 0x3acccccd, v5
    v_mul_u32_u24 v6, 10, v40
    v_cvt_f32_u32 v6, v6
    v_mul_f32 v42, v41, v6
    s_mov_b32 s59, 0x00000000
    v_fma_f32 v10, v41, s59, v42
    v_cos_f32 v16, v10
    v_sin_f32 v17, v10
    s_mov_b32 s59, 0x3f800000
    v_fma_f32 v10, v41, s59, v42
    v_cos_f32 v18, v10
    v_sin_f32 v19, v10
    s_mov_b32 s59, 0x40000000
    v_fma_f32 v10, v41, s59, v42
    v_cos_f32 v20, v10
    v_sin_f32 v21, v10
    s_mov_b32 s59, 0x40400000
    v_fma_f32 v10, v41, s59, v42
    v_cos_f32 v22, v10
    v_sin_f32 v23, v10
    s_mov_b32 s59, 0x40800000
    v_fma_f32 v10, v41, s59, v42
    v_cos_f32 v24, v10
    v_sin_f32 v25, v10
    s_mov_b32 s59, 0x40a00000
    v_fma_f32 v10, v41, s59, v42
    v_cos_f32 v26, v10
    v_sin_f32 v27, v10
    s_nop 0
    ds_write_b128 v198, v[16:19] offset:4096
    ds_write_b128 v198, v[20:23] offset:5120
    ds_write_b128 v198, v[24:27] offset:6144
    s_branch TMKE_11
TMK_19:
    v_and_b32 v2, 31, v1
    v_lshrrev_b32 v40, 5, v1
    v_cvt_f32_u32 v5, v2
    v_mul_f32 v41, 0x3acccccd, v5
    v_mul_u32_u24 v6, 10, v40
    v_cvt_f32_u32 v6, v6
    v_mul_f32 v42, v41, v6
    s_mov_b32 s59, 0x40c00000
    v_fma_f32 v10, v41, s59, v42
    v_cos_f32 v28, v10
    v_sin_f32 v29, v10
    s_mov_b32 s59, 0x40e00000
    v_fma_f32 v10, v41, s59, v42
    v_cos_f32 v30, v10
    v_sin_f32 v31, v10
    s_mov_b32 s59, 0x41000000
    v_fma_f32 v10, v41, s59, v42
    v_cos_f32 v32, v10
    v_sin_f32 v33, v10
    s_mov_b32 s59, 0x41100000
    v_fma_f32 v10, v41, s59, v42
    v_cos_f32 v34, v10
    v_sin_f32 v35, v10
    v_mul_f32 v10, 0x41a00000, v41
    v_cos_f32 v36, v10
    v_sin_f32 v37, v10
    s_nop 0
    ds_write_b128 v198, v[28:31] offset:7168
    ds_write_b128 v198, v[32:35] offset:8192
    ds_write_b128 v198, v[36:39] offset:9216
TMKE_11:
    v_lshlrev_b32 v45, 4, v1
    s_mul_i32 s58, s66, 40960
    s_lshl_b32 s59, s40, 11
    s_add_u32 s58, s58, s59
    s_add_u32 s58, s58, 3145728
    s_add_u32 m0, s59, 36864
    s_nop 0
    buffer_load_dwordx4 v45, s[36:39], s58 offen offset:0 sc1 lds
    buffer_load_dwordx4 v45, s[36:39], s58 offen offset:1024 sc1 lds
    s_add_u32 m0, m0, 16384
    s_add_u32 s58, s58, 16384
    buffer_load_dwordx4 v45, s[36:39], s58 offen offset:0 sc1 lds
    buffer_load_dwordx4 v45, s[36:39], s58 offen offset:1024 sc1 lds
    s_cmp_lt_u32 s40, 4
    s_cselect_b32 s59, 16384, 0
    s_add_u32 m0, m0, s59
    s_add_u32 s58, s58, s59
    buffer_load_dwordx4 v45, s[36:39], s58 offen offset:0 sc1 lds
    buffer_load_dwordx4 v45, s[36:39], s58 offen offset:1024 sc1 lds
    s_waitcnt vmcnt(6) lgkmcnt(0)
    s_barrier
    s_cmp_eq_u32 s40, 0
    s_cbranch_scc0 NOKVSIG_20
    s_lshl_b32 s60, s42, 10
    s_add_u32 s60, s60, 139264
    v_lshlrev_b32 v2, 8, v1
    v_mov_b32 v3, 1
    s_mov_b64 exec, 15
    buffer_atomic_add v3, v2, s[36:39], s60 offen
    s_mov_b64 exec, -1
NOKVSIG_20:
    s_waitcnt vmcnt(1)
    s_cmp_eq_u32 s40, 0
    s_cbranch_scc1 UW_21
    s_waitcnt vmcnt(0)
UW_21:
L_B2:
    ds_read_b128 v[104:107], v208 offset:6144
    ds_read_b128 v[108:111], v208 offset:7168
    ds_read_b32 v16, v199 offset:0
    ds_read_b32 v17, v199 offset:128
    ds_read_b32 v18, v199 offset:256
    ds_read_b32 v19, v199 offset:384
    ds_read_b32 v20, v199 offset:64
    ds_read_b32 v21, v199 offset:192
    ds_read_b32 v22, v199 offset:320
    ds_read_b32 v23, v199 offset:448
    ds_read_b32 v24, v199 offset:16384
    ds_read_b32 v25, v199 offset:16512
    ds_read_b32 v26, v199 offset:16640
    ds_read_b32 v27, v199 offset:16768
    s_waitcnt lgkmcnt(7)
    ds_read_b32 v28, v199 offset:16448
    ds_read_b32 v29, v199 offset:16576
    ds_read_b32 v30, v199 offset:16704
    ds_read_b32 v31, v199 offset:16832
    ds_read_b32 v32, v199 offset:32768
    ds_read_b32 v33, v199 offset:32896
    ds_read_b32 v34, v199 offset:33024
    ds_read_b32 v35, v199 offset:33152
    s_waitcnt lgkmcnt(7)
    ds_read_b32 v36, v199 offset:32832
    ds_read_b32 v37, v199 offset:32960
    ds_read_b32 v38, v199 offset:33088
    ds_read_b32 v39, v199 offset:33216
    s_waitcnt lgkmcnt(15)
    v_mfma_f32_16x16x32_bf16 v[136:139], v[16:19], v[104:107], 0
    s_waitcnt lgkmcnt(15)
    v_mfma_f32_16x16x32_bf16 v[140:143], v[20:23], v[104:107], 0
    s_waitcnt lgkmcnt(12)
    v_mfma_f32_16x16x32_bf16 v[144:147], v[24:27], v[104:107], 0
    s_waitcnt lgkmcnt(8)
    v_mfma_f32_16x16x32_bf16 v[148:151], v[28:31], v[104:107], 0
    s_waitcnt lgkmcnt(4)
    v_mfma_f32_16x16x32_bf16 v[152:155], v[32:35], v[104:107], 0
    s_waitcnt lgkmcnt(0)
    v_mfma_f32_16x16x32_bf16 v[156:159], v[36:39], v[104:107], 0
    s_lshr_b32 s58, s45, 2
    s_mul_i32 s58, s58, 160
    s_mul_i32 s59, s40, 40960
    s_add_u32 s58, s58, s59
    s_add_u32 s58, s58, 327680
    s_mul_i32 s59, s40, 5120
    s_add_u32 m0, s59, 77824
    s_nop 0
    buffer_load_dwordx4 v245, s[20:23], s58 offen lds
    buffer_load_dwordx4 v246, s[20:23], s58 offen offset:1024 lds
    buffer_load_dwordx4 v247, s[20:23], s58 offen offset:2048 lds
    buffer_load_dwordx4 v248, s[20:23], s58 offen offset:3072 lds
    s_add_u32 m0, m0, 4096
    s_nop 0
    buffer_load_dwordx4 v249, s[20:23], s58 offen lds
    s_cmp_ge_u32 s40, 4
    s_cbranch_scc1 WOE_22
    s_add_u32 s58, s58, 327680
    s_add_u32 m0, m0, 36864
    s_nop 0
    buffer_load_dwordx4 v245, s[20:23], s58 offen offset:0 lds
    buffer_load_dwordx4 v246, s[20:23], s58 offen offset:1024 lds
    buffer_load_dwordx4 v247, s[20:23], s58 offen offset:2048 lds
    buffer_load_dwordx4 v248, s[20:23], s58 offen offset:3072 lds
    s_add_u32 m0, m0, 4096
    s_nop 0
    buffer_load_dwordx4 v249, s[20:23], s58 offen lds
WOE_22:
    v_cvt_pk_bf16_f32 v112, v136, v137
    v_cvt_pk_bf16_f32 v113, v138, v139
    ds_write_b64 v200, v[112:113] offset:0
    v_cvt_pk_bf16_f32 v114, v140, v141
    v_cvt_pk_bf16_f32 v115, v142, v143
    ds_write_b64 v200, v[114:115] offset:32
    v_cvt_pk_bf16_f32 v116, v144, v145
    v_cvt_pk_bf16_f32 v117, v146, v147
    ds_write_b64 v200, v[116:117] offset:512
    v_cvt_pk_bf16_f32 v118, v148, v149
    v_cvt_pk_bf16_f32 v119, v150, v151
    ds_write_b64 v200, v[118:119] offset:544
    s_cmp_ge_u32 s40, 4
    s_cbranch_scc1 ZDONE_23
    v_cvt_pk_bf16_f32 v120, v152, v153
    v_cvt_pk_bf16_f32 v121, v154, v155
    ds_write_b64 v200, v[120:121] offset:1024
    v_cvt_pk_bf16_f32 v122, v156, v157
    v_cvt_pk_bf16_f32 v123, v158, v159
    ds_write_b64 v200, v[122:123] offset:1056
ZDONE_23:
    s_cmp_lg_u32 s2, 0
    s_cbranch_scc1 NOZX_24
    v_mfma_f32_16x16x32_bf16 v[136:139], v[16:19], v[108:111], 0
    v_mfma_f32_16x16x32_bf16 v[140:143], v[20:23], v[108:111], 0
    v_mfma_f32_16x16x32_bf16 v[144:147], v[24:27], v[108:111], 0
    v_mfma_f32_16x16x32_bf16 v[148:151], v[28:31], v[108:111], 0
    v_mfma_f32_16x16x32_bf16 v[152:155], v[32:35], v[108:111], 0
    v_mfma_f32_16x16x32_bf16 v[156:159], v[36:39], v[108:111], 0
    s_mov_b32 s64, 0x30003
    s_mov_b32 s65, 0x30003
    s_waitcnt lgkmcnt(0)
    s_mov_b64 exec, s[64:65]
    v_cvt_pk_bf16_f32 v112, v136, v137
    v_cvt_pk_bf16_f32 v113, v138, v139
    ds_write_b64 v200, v[112:113] offset:20608
    v_cvt_pk_bf16_f32 v114, v140, v141
    v_cvt_pk_bf16_f32 v115, v142, v143
    ds_write_b64 v200, v[114:115] offset:20640
    v_cvt_pk_bf16_f32 v116, v144, v145
    v_cvt_pk_bf16_f32 v117, v146, v147
    ds_write_b64 v200, v[116:117] offset:21120
    v_cvt_pk_bf16_f32 v118, v148, v149
    v_cvt_pk_bf16_f32 v119, v150, v151
    ds_write_b64 v200, v[118:119] offset:21152
    s_cmp_ge_u32 s40, 4
    s_cbranch_scc1 ZDONE_25
    v_cvt_pk_bf16_f32 v120, v152, v153
    v_cvt_pk_bf16_f32 v121, v154, v155
    ds_write_b64 v200, v[120:121] offset:21632
    v_cvt_pk_bf16_f32 v122, v156, v157
    v_cvt_pk_bf16_f32 v123, v158, v159
    ds_write_b64 v200, v[122:123] offset:21664
ZDONE_25:
    s_mov_b64 exec, -1
NOZX_24:
    s_cmp_eq_u32 s62, 0
    s_cbranch_scc0 NOFPZ_26
    s_mov_b32 s56, s67
    v_lshrrev_b32 v2, 5, v1
    v_bfe_u32 v3, v1, 4, 1
    v_and_b32 v9, 15, v1
    v_lshlrev_b32 v4, 10, v2
    v_lshl_add_u32 v4, v3, 9, v4
    v_lshl_add_u32 v209, v9, 4, v4
    v_mul_u32_u24 v5, 5120, v2
    v_lshl_add_u32 v5, v3, 8, v5
    v_lshl_add_u32 v210, v9, 3, v5
    v_bfe_u32 v10, v1, 2, 2
    v_and_b32 v11, 3, v1
    v_mul_u32_u24 v12, 20, v3
    v_add_u32 v12, v12, v10
    v_lshl_add_u32 v6, v2, 3, v12
    v_mul_u32_u24 v6, 160, v6
    v_lshl_add_u32 v6, v11, 3, v6
    v_mul_u32_u24 v7, 80, v2
    v_add3_u32 v7, v7, v12, 16
    v_mul_u32_u24 v7, 160, v7
    v_lshl_add_u32 v7, v11, 3, v7
    s_mul_i32 s66, s62, 51200
    s_add_u32 s66, s66, 36864
    v_add_u32 v211, s66, v6
    v_add_u32 v212, s66, v7
    s_and_b32 s66, s45, 3
    s_lshl2_add_u32 s66, s44, s66
    s_lshr_b32 s3, s66, 1
    s_bfe_u32 s68, s45, 0x20002
    s_lshl2_add_u32 s3, s3, s68
    s_lshl_b32 s3, s3, 8
    s_add_u32 s3, s3, 147456
    s_lshr_b32 s68, s47, 1
    s_lshl1_add_u32 s67, s66, s68
    s_lshl1_add_u32 s67, s67, s62
    s_mul_i32 s67, s67, 20480
    s_add_u32 s67, s67, 524288
    s_and_b32 s68, s47, 1
    s_lshl_b32 s69, s68, 7
    s_add_u32 s69, s69, s67
    s_add_u32 s4, s69, 4096
    s_lshl_b32 s68, s68, 8
    s_add_u32 s5, s67, s68
    s_lshl2_add_u32 s66, s66, s47
    s_mul_i32 s66, s66, 40960
    s_lshr_b32 s68, s45, 2
    s_mul_i32 s68, s68, 160
    s_add_u32 s6, s66, s68
    v_mul_u32_u24 v8, 2560, v9
    v_lshrrev_b32 v2, 4, v1
    v_lshl_add_u32 v213, v2, 3, v8
    v_lshrrev_b32 v2, 5, v1
    v_lshl_add_u32 v8, v3, 5, v8
    v_lshl_add_u32 v215, v2, 4, v8
    s_mul_i32 s66, s47, 5120
    s_add_u32 s66, s66, 0
    v_lshl_add_u32 v214, v1, 4, s66
    s_mov_b32 s67, s56
NOFPZ_26:
    s_waitcnt lgkmcnt(8)
    ds_read_b128 v[40:43], v208 offset:0
    ds_read_b128 v[44:47], v208 offset:1024
    ds_read_b128 v[48:51], v208 offset:2048
    ds_read_b128 v[52:55], v208 offset:3072
    ds_read_b128 v[56:59], v208 offset:4096
    ds_read_b128 v[60:63], v208 offset:5120
    s_waitcnt lgkmcnt(0)
    s_barrier
    s_mov_b32 s48, s40
L_B2ROW:
    ds_read_b64_tr_b16 v[16:17], v201
    ds_read_b64_tr_b16 v[18:19], v201 offset:256
    ds_read_b64_tr_b16 v[20:21], v202 offset:1024
    ds_read_b64_tr_b16 v[22:23], v201 offset:1288
    ds_read_b64_tr_b16 v[24:25], v204 offset:2056
    ds_read_b64_tr_b16 v[26:27], v204 offset:2312
    ds_read_b128 v[80:83], v198 offset:4096
    ds_read_b128 v[84:87], v198 offset:5120
    ds_read_b128 v[88:91], v198 offset:6144
    ds_read_b128 v[92:95], v198 offset:7168
    ds_read_b128 v[96:99], v198 offset:8192
    ds_read_b128 v[100:103], v198 offset:9216
    ds_read_b128 v[64:67], v198 offset:0
    ds_read_b128 v[68:71], v198 offset:1024
    ds_read_b128 v[72:75], v198 offset:2048
    s_lshr_b32 s58, s45, 2
    s_mul_i32 s58, s58, 160
    s_mul_i32 s59, s40, 40960
    s_add_u32 s58, s58, s59
    s_add_u32 s58, s58, 0
    s_mul_i32 s59, s40, 5120
    s_add_u32 m0, s59, 36864
    s_nop 0
    buffer_load_dwordx4 v245, s[20:23], s58 offen lds
    buffer_load_dwordx4 v246, s[20:23], s58 offen offset:1024 lds
    buffer_load_dwordx4 v247, s[20:23], s58 offen offset:2048 lds
    buffer_load_dwordx4 v248, s[20:23], s58 offen offset:3072 lds
    s_add_u32 m0, m0, 4096
    s_nop 0
    buffer_load_dwordx4 v249, s[20:23], s58 offen lds
    s_add_u32 s68, s67, s48
    s_lshl_b32 s68, s68, 7
    s_add_u32 s68, s68, s46
    s_sub_u32 s69, 2048, s68
    s_and_b32 s69, s69, 2047
    s_mul_i32 s68, s68, 2560
    s_mul_i32 s69, s69, 2560
    s_waitcnt lgkmcnt(13)
    v_mfma_f32_32x32x16_bf16 v[112:127], v[40:43], v[16:19], 0
    v_mfma_f32_32x32x16_bf16 v[128:143], v[52:55], v[16:19], 0
    s_waitcnt lgkmcnt(11)
    v_mfma_f32_32x32x16_bf16 v[112:127], v[44:47], v[20:23], v[112:127]
    v_mfma_f32_32x32x16_bf16 v[128:143], v[56:59], v[20:23], v[128:143]
    s_waitcnt lgkmcnt(9)
    v_mfma_f32_32x32x16_bf16 v[112:127], v[48:51], v[24:27], v[112:127]
    v_mfma_f32_32x32x16_bf16 v[128:143], v[60:63], v[24:27], v[128:143]
    ds_read_b128 v[76:79], v198 offset:3072
    s_nop 7
    s_nop 1
    s_waitcnt lgkmcnt(4)
    v_mul_f32 v160, v112, v80
    v_mul_f32 v161, v113, v80
    v_fma_f32 v160, v113, v81, v160
    v_fma_f32 v161, -v112, v81, v161
    v_cvt_pk_bf16_f32 v162, v160, v161
    ds_write_b32 v203, v162 offset:0
    v_mul_f32 v163, v114, v82
    v_mul_f32 v164, v115, v82
    v_fma_f32 v163, v115, v83, v163
    v_fma_f32 v164, -v114, v83, v164
    v_cvt_pk_bf16_f32 v165, v163, v164
    ds_write_b32 v203, v165 offset:144
    v_mul_f32 v166, v116, v84
    v_mul_f32 v167, v117, v84
    v_fma_f32 v166, v117, v85, v166
    v_fma_f32 v167, -v116, v85, v167
    v_cvt_pk_bf16_f32 v168, v166, v167
    ds_write_b32 v203, v168 offset:288
    v_mul_f32 v169, v118, v86
    v_mul_f32 v170, v119, v86
    v_fma_f32 v169, v119, v87, v169
    v_fma_f32 v170, -v118, v87, v170
    v_cvt_pk_bf16_f32 v171, v169, v170
    ds_write_b32 v203, v171 offset:432
    v_mul_f32 v172, v120, v88
    v_mul_f32 v173, v121, v88
    v_fma_f32 v172, v121, v89, v172
    v_fma_f32 v173, -v120, v89, v173
    v_cvt_pk_bf16_f32 v174, v172, v173
    ds_write_b32 v203, v174 offset:576
    v_mul_f32 v175, v122, v90
    v_mul_f32 v176, v123, v90
    v_fma_f32 v175, v123, v91, v175
    v_fma_f32 v176, -v122, v91, v176
    v_cvt_pk_bf16_f32 v177, v175, v176
    ds_write_b32 v203, v177 offset:720
    v_mul_f32 v178, v124, v92
    v_mul_f32 v179, v125, v92
    v_fma_f32 v178, v125, v93, v178
    v_fma_f32 v179, -v124, v93, v179
    v_cvt_pk_bf16_f32 v180, v178, v179
    ds_write_b32 v203, v180 offset:864
    v_mul_f32 v181, v126, v94
    v_mul_f32 v182, v127, v94
    v_fma_f32 v181, v127, v95, v181
    v_fma_f32 v182, -v126, v95, v182
    v_cvt_pk_bf16_f32 v183, v181, v182
    ds_write_b32 v203, v183 offset:1008
    v_mul_f32 v184, v128, v96
    v_mul_f32 v185, v129, v96
    v_fma_f32 v184, v129, v97, v184
    v_fma_f32 v185, -v128, v97, v185
    v_cvt_pk_bf16_f32 v186, v184, v185
    ds_write_b32 v203, v186 offset:1152
    v_mul_f32 v187, v130, v98
    v_mul_f32 v188, v131, v98
    v_fma_f32 v187, v131, v99, v187
    v_fma_f32 v188, -v130, v99, v188
    v_cvt_pk_bf16_f32 v189, v187, v188
    ds_write_b32 v203, v189 offset:1296
    v_mul_f32 v190, v112, v100
    v_mul_f32 v191, v113, v100
    v_fma_f32 v190, v113, v101, v190
    v_fma_f32 v191, -v112, v101, v191
    v_cvt_pk_bf16_f32 v192, v190, v191
    s_mov_b32 exec_hi, 0
    ds_write_b32 v203, v192 offset:2880
    s_mov_b64 exec, -1
    s_waitcnt lgkmcnt(0)
    ds_read_b128 v[16:19], v205 offset:0
    ds_read_b128 v[20:23], v205 offset:32
    ds_read_b128 v[24:27], v205 offset:64
    ds_read_b128 v[28:31], v205 offset:96
    s_waitcnt lgkmcnt(3)
    v_mfma_f32_32x32x16_bf16 v[112:127], v[16:19], v[64:67], 0
    s_waitcnt lgkmcnt(2)
    v_mfma_f32_32x32x16_bf16 v[112:127], v[20:23], v[68:71], v[112:127]
    s_waitcnt lgkmcnt(1)
    v_mfma_f32_32x32x16_bf16 v[112:127], v[24:27], v[72:75], v[112:127]
    s_waitcnt lgkmcnt(0)
    v_mfma_f32_32x32x16_bf16 v[112:127], v[28:31], v[76:79], v[112:127]
    s_nop 7
    s_nop 3
    v_cvt_pk_bf16_f32 v32, v112, v113
    v_cvt_pk_bf16_f32 v33, v114, v115
    v_cvt_pk_bf16_f32 v34, v116, v117
    v_cvt_pk_bf16_f32 v35, v118, v119
    v_cvt_pk_bf16_f32 v36, v120, v121
    v_cvt_pk_bf16_f32 v128, v122, v121
    v_cvt_pk_bf16_f32 v129, v120, v119
    v_cvt_pk_bf16_f32 v130, v118, v117
    v_cvt_pk_bf16_f32 v131, v116, v115
    v_cvt_pk_bf16_f32 v132, v114, v113
    buffer_store_dwordx4 v[32:35], v206, s[28:31], s68 offen nt
    buffer_store_dword v36, v206, s[28:31], s68 offen offset:16 nt
    buffer_store_dwordx4 v[128:131], v207, s[28:31], s69 offen nt
    buffer_store_dword v132, v207, s[28:31], s69 offen offset:16 nt
    s_or_b32 s60, s2, s48
    s_cbranch_scc1 NOYST_27
    s_mov_b32 s48, 8
    v_add_u32 v201, 20608, v201
    v_add_u32 v202, 20608, v202
    v_add_u32 v204, 20608, v204
    s_branch L_B2ROW
NOYST_27:
    s_waitcnt vmcnt(4) lgkmcnt(0)
    s_barrier
    s_cmp_eq_u32 s40, 1
    s_cbranch_scc0 NOOL_28
    v_mov_b32 v2, 0
    v_mov_b32 v252, 0
    s_mov_b64 exec, 1
    buffer_atomic_add v252, v2, s[36:39], s3 offen sc0
    s_mov_b64 exec, -1
NOOL_28:
    ds_read_b64_tr_b16 v[108:109], v211 offset:0
    ds_read_b64_tr_b16 v[110:111], v211 offset:640
    ds_read_b64_tr_b16 v[112:113], v211 offset:32
    ds_read_b64_tr_b16 v[114:115], v211 offset:672
    ds_read_b64_tr_b16 v[116:117], v211 offset:64
    ds_read_b64_tr_b16 v[118:119], v211 offset:704
    ds_read_b64_tr_b16 v[120:121], v211 offset:96
    ds_read_b64_tr_b16 v[122:123], v211 offset:736
    ds_read_b64_tr_b16 v[124:125], v211 offset:128
    ds_read_b64_tr_b16 v[126:127], v211 offset:768
    s_waitcnt lgkmcnt(5)
    ds_read_b64_tr_b16 v[128:129], v211 offset:6400
    ds_read_b64_tr_b16 v[130:131], v211 offset:7040
    ds_read_b64_tr_b16 v[132:133], v211 offset:6432
    ds_read_b64_tr_b16 v[134:135], v211 offset:7072
    ds_read_b64_tr_b16 v[136:137], v211 offset:6464
    ds_read_b64_tr_b16 v[138:139], v211 offset:7104
    ds_read_b64_tr_b16 v[140:141], v211 offset:6496
    ds_read_b64_tr_b16 v[142:143], v211 offset:7136
    ds_read_b64_tr_b16 v[144:145], v211 offset:6528
    ds_read_b64_tr_b16 v[146:147], v211 offset:7168
    s_waitcnt lgkmcnt(5)
    ds_read_b64_tr_b16 v[148:149], v211 offset:12800
    ds_read_b64_tr_b16 v[150:151], v211 offset:13440
    ds_read_b64_tr_b16 v[152:153], v211 offset:12832
    ds_read_b64_tr_b16 v[154:155], v211 offset:13472
    ds_read_b64_tr_b16 v[156:157], v211 offset:12864
    ds_read_b64_tr_b16 v[158:159], v211 offset:13504
    ds_read_b64_tr_b16 v[160:161], v211 offset:12896
    ds_read_b64_tr_b16 v[162:163], v211 offset:13536
    ds_read_b64_tr_b16 v[164:165], v211 offset:12928
    ds_read_b64_tr_b16 v[166:167], v211 offset:13568
    s_branch L_FINAL
L_QB:
    s_waitcnt lgkmcnt(0)
    s_mov_b32 s26, 2621440
    s_mov_b32 s27, 0x20000
    s_mov_b32 s38, 16777216
    s_mov_b32 s39, 0x20000
    s_mov_b32 s18, 25600
    s_mov_b32 s19, 0x20000
    s_mov_b32 s22, 819200
    s_mov_b32 s23, 0x20000
    s_mov_b32 s30, 5242880
    s_mov_b32 s31, 0x20000
    s_mov_b32 s34, 256
    s_mov_b32 s35, 0x20000
    s_mov_b64 s[16:17], s[4:5]
    s_mov_b64 s[20:21], s[6:7]
    s_mov_b64 s[28:29], s[56:57]
    s_mov_b64 s[32:33], s[58:59]
    s_cmp_ge_u32 s40, 4
    s_cbranch_scc0 L_QB_CP
    s_cmp_ge_u32 s2, 208
    s_cbranch_scc1 L_ZL
    s_sub_u32 s66, s2, 128
    s_mul_i32 s67, s66, 205
    s_lshr_b32 s67, s67, 10
    s_mul_i32 s68, s67, 5
    s_sub_u32 s68, s66, s68
    v_lshrrev_b32 v2, 4, v1
    v_and_b32 v3, 15, v1
    v_lshlrev_b32 v9, 2, v2
    v_xor_b32 v3, v3, v9
    v_mul_u32_u24 v2, 20480, v2
    v_lshl_add_u32 v4, v3, 4, v2
    v_add_u32 v5, 80896, v4
    v_add_u32 v6, 161792, v4
    v_add_u32 v7, 242688, v4
    s_lshl_b32 s69, s47, 9
    s_add_u32 s69, s69, s67
    s_mul_i32 s69, s69, 1280
    s_lshl_b32 s70, s68, 8
    s_add_u32 s69, s69, s70
    s_lshl_b32 s70, s47, 13
    s_add_u32 m0, s70, 114688
    s_nop 0
    buffer_load_dwordx4 v4, s[24:27], s69 offen offset:0 lds
    buffer_load_dwordx4 v5, s[24:27], s69 offen offset:1024 lds
    buffer_load_dwordx4 v6, s[24:27], s69 offen offset:2048 lds
    buffer_load_dwordx4 v7, s[24:27], s69 offen offset:3072 lds
    s_add_u32 m0, m0, 4096
    s_add_u32 s69, s69, 327680
    buffer_load_dwordx4 v4, s[24:27], s69 offen offset:0 lds
    buffer_load_dwordx4 v5, s[24:27], s69 offen offset:1024 lds
    buffer_load_dwordx4 v6, s[24:27], s69 offen offset:2048 lds
    buffer_load_dwordx4 v7, s[24:27], s69 offen offset:3072 lds
    s_lshl2_add_u32 s66, s43, s47
    s_add_u32 s66, s66, -24
    s_max_i32 s68, s66, -8
    s_add_u32 s68, s68, 10
    s_mul_i32 s67, s68, 205
    s_lshr_b32 s67, s67, 11
    s_lshl3_add_u32 s66, s67, s66
    s_add_u32 s66, s66, 90
    s_min_u32 s66, s66, 188
    s_mul_i32 s67, s66, 3641
    s_lshr_b32 s67, s67, 16
    s_mul_i32 s68, s67, 18
    s_sub_u32 s68, s66, s68
    s_cmp_ge_u32 s68, 8
    s_cbranch_scc1 PFW_30
    s_and_b32 s69, s44, 3
    s_lshl_b32 s69, s69, 3
    s_add_u32 s69, s69, s68
    s_mul_i32 s69, s69, 81920
    s_lshl_b32 s67, s67, 7
    s_add_u32 s69, s69, s67
    v_mul_u32_u24 v250, 1280, v1
    buffer_load_dword v251, v250, s[8:11], s69 offen
    s_branch NOPF_29
PFW_30:
    s_sub_u32 s68, s68, 8
    s_cmp_ge_u32 s68, 5
    s_cselect_b32 s69, 640, 0
    s_lshl_b32 s68, s68, 7
    s_add_u32 s69, s69, s68
    s_lshr_b32 s68, s44, 2
    s_mul_i32 s68, s68, 640
    s_add_u32 s69, s69, s68
    s_mul_i32 s67, s67, 245760
    s_add_u32 s69, s69, s67
    s_add_u32 s69, s69, 1280
    v_mul_u32_u24 v250, 3840, v1
    buffer_load_dword v251, v250, s[12:15], s69 offen
NOPF_29:
    v_lshrrev_b32 v2, 3, v1
    v_and_b32 v3, 7, v1
    v_lshrrev_b32 v13, 4, v1
    v_xor_b32 v3, v3, v13
    v_mul_u32_u24 v2, 1280, v2
    v_lshl_add_u32 v236, v3, 4, v2
    v_xor_b32 v3, 64, v236
    v_add_u32 v237, 9216, v3
    v_add_u32 v238, 18432, v236
    v_add_u32 v239, 27648, v3
    s_lshl2_add_u32 s50, s41, s47
    s_mul_i32 s50, s50, 40960
    s_lshl_b32 s49, s47, 12
    s_mul_i32 s53, s47, -1024
    s_add_u32 s53, s53, 16384
    s_mul_i32 s51, s47, 61440
    s_mul_i32 s66, s42, 160
    s_add_u32 s51, s51, s66
    s_add_u32 s66, s41, s42
    s_and_b32 s66, s66, 3
    s_lshl_b32 s66, s66, 2
    s_lshr_b32 s52, 0x3975, s66
    s_and_b32 s52, s52, 15
    s_lshl_b32 s66, s52, 7
    s_add_u32 s50, s50, s66
    s_mul_i32 s66, s52, 245760
    s_add_u32 s51, s51, s66
    v_mov_b32 v14, 1073741824
    v_add_u32 v4, 0, v1
    v_add_u32 v5, 64, v1
    v_add_u32 v6, 128, v1
    v_mul_u32_u24 v240, 5462, v4
    v_mul_u32_u24 v241, 5462, v5
    v_mul_u32_u24 v242, 5462, v6
    v_lshrrev_b32 v240, 16, v240
    v_lshrrev_b32 v241, 16, v241
    v_lshrrev_b32 v242, 16, v242
    s_movk_i32 s66, -12
    v_mad_i32_i24 v4, v240, s66, v4
    v_mad_i32_i24 v5, v241, s66, v5
    v_mad_i32_i24 v6, v242, s66, v6
    v_bfe_u32 v9, v240, 3, 1
    v_bfe_u32 v10, v241, 3, 1
    v_bfe_u32 v11, v242, 3, 1
    v_lshlrev_b32 v9, 1, v9
    v_lshlrev_b32 v10, 1, v10
    v_lshlrev_b32 v11, 1, v11
    v_xor_b32 v4, v4, v9
    v_xor_b32 v5, v5, v10
    v_xor_b32 v6, v6, v11
    v_cmp_lt_u32 vcc, 9, v4
    v_mul_u32_u24 v240, 3840, v240
    v_lshl_add_u32 v240, v4, 4, v240
    v_cndmask_b32 v4, 0, v14, vcc
    v_add_u32 v240, v240, v4
    v_cmp_lt_u32 vcc, 9, v5
    v_mul_u32_u24 v241, 3840, v241
    v_lshl_add_u32 v241, v5, 4, v241
    v_cndmask_b32 v5, 0, v14, vcc
    v_subrev_u32 v241, 1024, v241
    v_add_u32 v241, v241, v5
    v_cmp_lt_u32 vcc, 9, v6
    v_mul_u32_u24 v242, 3840, v242
    v_lshl_add_u32 v242, v6, 4, v242
    v_cndmask_b32 v6, 0, v14, vcc
    v_subrev_u32 v242, 2048, v242
    v_add_u32 v242, v242, v6
    s_mul_i32 s66, s47, 3072
    s_add_u32 s66, s66, 139392
    v_lshl_add_u32 v188, v1, 4, s66
    v_bfe_u32 v10, v1, 4, 1
    v_bfe_u32 v11, v1, 2, 2
    v_and_b32 v12, 3, v1
    v_lshrrev_b32 v9, 5, v1
    v_lshl_add_u32 v13, v10, 2, v12
    v_lshl_add_u32 v14, v9, 3, v11
    v_mul_u32_u24 v14, 80, v14
    v_lshl_add_u32 v14, v13, 3, v14
    s_mul_i32 s66, s62, 3840
    s_add_u32 s66, s66, 156160
    v_add_u32 v189, s66, v14
    v_mov_b32 v193, 0x40000000
    v_mov_b32 v194, 0x40000000
    v_add_u32 v4, 0, v1
    v_add_u32 v5, 64, v1
    v_add_u32 v6, 128, v1
    v_add_u32 v7, 192, v1
    v_add_u32 v8, 256, v1
    v_mul_u32_u24 v245, 6554, v4
    v_mul_u32_u24 v246, 6554, v5
    v_mul_u32_u24 v247, 6554, v6
    v_mul_u32_u24 v248, 6554, v7
    v_mul_u32_u24 v249, 6554, v8
    v_lshrrev_b32 v245, 16, v245
    v_lshrrev_b32 v246, 16, v246
    v_lshrrev_b32 v247, 16, v247
    v_lshrrev_b32 v248, 16, v248
    v_lshrrev_b32 v249, 16, v249
    v_mul_u32_u24 v245, 1120, v245
    v_mul_u32_u24 v246, 1120, v246
    v_mul_u32_u24 v247, 1120, v247
    v_mul_u32_u24 v248, 1120, v248
    v_mul_u32_u24 v249, 1120, v249
    v_lshl_add_u32 v245, v4, 4, v245
    v_lshl_add_u32 v246, v5, 4, v246
    v_lshl_add_u32 v247, v6, 4, v247
    v_lshl_add_u32 v248, v7, 4, v248
    v_lshl_add_u32 v249, v8, 4, v249
    v_subrev_u32 v246, 1024, v246
    v_subrev_u32 v247, 2048, v247
    v_subrev_u32 v248, 3072, v248
    s_waitcnt vmcnt(1)
    s_barrier
    s_branch L_ZL2
L_ZL:
    s_lshl2_add_u32 s66, s43, s47
    s_add_u32 s66, s66, -112
    s_max_i32 s68, s66, -8
    s_add_u32 s68, s68, 10
    s_mul_i32 s67, s68, 205
    s_lshr_b32 s67, s67, 11
    s_lshl3_add_u32 s66, s67, s66
    s_add_u32 s66, s66, 90
    s_min_u32 s66, s66, 188
    s_mul_i32 s67, s66, 3641
    s_lshr_b32 s67, s67, 16
    s_mul_i32 s68, s67, 18
    s_sub_u32 s68, s66, s68
    s_cmp_ge_u32 s68, 8
    s_cbranch_scc1 PFW_32
    s_and_b32 s69, s44, 3
    s_lshl_b32 s69, s69, 3
    s_add_u32 s69, s69, s68
    s_mul_i32 s69, s69, 81920
    s_lshl_b32 s67, s67, 7
    s_add_u32 s69, s69, s67
    v_mul_u32_u24 v250, 1280, v1
    buffer_load_dword v251, v250, s[8:11], s69 offen
    s_branch NOPF_31
PFW_32:
    s_sub_u32 s68, s68, 8
    s_cmp_ge_u32 s68, 5
    s_cselect_b32 s69, 640, 0
    s_lshl_b32 s68, s68, 7
    s_add_u32 s69, s69, s68
    s_lshr_b32 s68, s44, 2
    s_mul_i32 s68, s68, 640
    s_add_u32 s69, s69, s68
    s_mul_i32 s67, s67, 245760
    s_add_u32 s69, s69, s67
    s_add_u32 s69, s69, 1280
    v_mul_u32_u24 v250, 3840, v1
    buffer_load_dword v251, v250, s[12:15], s69 offen
NOPF_31:
    s_lshl2_add_u32 s66, s43, s47
    s_add_u32 s66, s66, -88
    s_max_i32 s68, s66, -8
    s_add_u32 s68, s68, 10
    s_mul_i32 s67, s68, 205
    s_lshr_b32 s67, s67, 11
    s_lshl3_add_u32 s66, s67, s66
    s_add_u32 s66, s66, 90
    s_min_u32 s66, s66, 188
    s_mul_i32 s67, s66, 3641
    s_lshr_b32 s67, s67, 16
    s_mul_i32 s68, s67, 18
    s_sub_u32 s68, s66, s68
    s_cmp_ge_u32 s68, 8
    s_cbranch_scc1 PFW_34
    s_and_b32 s69, s44, 3
    s_lshl_b32 s69, s69, 3
    s_add_u32 s69, s69, s68
    s_mul_i32 s69, s69, 81920
    s_lshl_b32 s67, s67, 7
    s_add_u32 s69, s69, s67
    v_mul_u32_u24 v250, 1280, v1
    buffer_load_dword v251, v250, s[8:11], s69 offen
    s_branch NOPF_33
PFW_34:
    s_sub_u32 s68, s68, 8
    s_cmp_ge_u32 s68, 5
    s_cselect_b32 s69, 640, 0
    s_lshl_b32 s68, s68, 7
    s_add_u32 s69, s69, s68
    s_lshr_b32 s68, s44, 2
    s_mul_i32 s68, s68, 640
    s_add_u32 s69, s69, s68
    s_mul_i32 s67, s67, 245760
    s_add_u32 s69, s69, s67
    s_add_u32 s69, s69, 1280
    v_mul_u32_u24 v250, 3840, v1
    buffer_load_dword v251, v250, s[12:15], s69 offen
NOPF_33:
    s_cmp_lg_u32 s40, 7
    s_cbranch_scc1 NOCW_35
    s_cmp_ge_u32 s43, 16
    s_cbranch_scc1 NOCW_35
    s_getpc_b64 s[56:57]
L_PCREF:
    s_sub_u32 s58, s43, 10
    s_lshl_b32 s58, s58, 13
    v_lshl_add_u32 v252, v1, 7, s58
    s_sub_u32 s56, s56, L_PCREF-L_TEXT0
    s_subb_u32 s57, s57, 0
    v_min_u32 v252, L_TEXTEND-L_TEXT0-4, v252
    v_mov_b32 v253, s57
    v_add_co_u32 v252, vcc, s56, v252
    s_nop 1
    v_addc_co_u32 v253, vcc, 0, v253, vcc
    global_load_dword v251, v[252:253], off
NOCW_35:
    v_lshrrev_b32 v2, 3, v1
    v_and_b32 v3, 7, v1
    v_lshrrev_b32 v13, 4, v1
    v_xor_b32 v3, v3, v13
    v_mul_u32_u24 v2, 1280, v2
    v_lshl_add_u32 v236, v3, 4, v2
    v_xor_b32 v3, 64, v236
    v_add_u32 v237, 9216, v3
    v_add_u32 v238, 18432, v236
    v_add_u32 v239, 27648, v3
    s_lshl2_add_u32 s50, s41, s47
    s_mul_i32 s50, s50, 40960
    s_lshl_b32 s49, s47, 12
    s_mul_i32 s53, s47, -1024
    s_add_u32 s53, s53, 16384
    s_mul_i32 s51, s47, 61440
    s_mul_i32 s66, s42, 160
    s_add_u32 s51, s51, s66
    s_add_u32 s66, s41, s42
    s_and_b32 s66, s66, 3
    s_lshl_b32 s66, s66, 2
    s_lshr_b32 s52, 0x3975, s66
    s_and_b32 s52, s52, 15
    s_lshl_b32 s66, s52, 7
    s_add_u32 s50, s50, s66
    s_mul_i32 s66, s52, 245760
    s_add_u32 s51, s51, s66
    v_mov_b32 v14, 1073741824
    v_add_u32 v4, 0, v1
    v_add_u32 v5, 64, v1
    v_add_u32 v6, 128, v1
    v_mul_u32_u24 v240, 5462, v4
    v_mul_u32_u24 v241, 5462, v5
    v_mul_u32_u24 v242, 5462, v6
    v_lshrrev_b32 v240, 16, v240
    v_lshrrev_b32 v241, 16, v241
    v_lshrrev_b32 v242, 16, v242
    s_movk_i32 s66, -12
    v_mad_i32_i24 v4, v240, s66, v4
    v_mad_i32_i24 v5, v241, s66, v5
    v_mad_i32_i24 v6, v242, s66, v6
    v_bfe_u32 v9, v240, 3, 1
    v_bfe_u32 v10, v241, 3, 1
    v_bfe_u32 v11, v242, 3, 1
    v_lshlrev_b32 v9, 1, v9
    v_lshlrev_b32 v10, 1, v10
    v_lshlrev_b32 v11, 1, v11
    v_xor_b32 v4, v4, v9
    v_xor_b32 v5, v5, v10
    v_xor_b32 v6, v6, v11
    v_cmp_lt_u32 vcc, 9, v4
    v_mul_u32_u24 v240, 3840, v240
    v_lshl_add_u32 v240, v4, 4, v240
    v_cndmask_b32 v4, 0, v14, vcc
    v_add_u32 v240, v240, v4
    v_cmp_lt_u32 vcc, 9, v5
    v_mul_u32_u24 v241, 3840, v241
    v_lshl_add_u32 v241, v5, 4, v241
    v_cndmask_b32 v5, 0, v14, vcc
    v_subrev_u32 v241, 1024, v241
    v_add_u32 v241, v241, v5
    v_cmp_lt_u32 vcc, 9, v6
    v_mul_u32_u24 v242, 3840, v242
    v_lshl_add_u32 v242, v6, 4, v242
    v_cndmask_b32 v6, 0, v14, vcc
    v_subrev_u32 v242, 2048, v242
    v_add_u32 v242, v242, v6
    s_mul_i32 s66, s47, 3072
    s_add_u32 s66, s66, 139392
    v_lshl_add_u32 v188, v1, 4, s66
    v_bfe_u32 v10, v1, 4, 1
    v_bfe_u32 v11, v1, 2, 2
    v_and_b32 v12, 3, v1
    v_lshrrev_b32 v9, 5, v1
    v_lshl_add_u32 v13, v10, 2, v12
    v_lshl_add_u32 v14, v9, 3, v11
    v_mul_u32_u24 v14, 80, v14
    v_lshl_add_u32 v14, v13, 3, v14
    s_mul_i32 s66, s62, 3840
    s_add_u32 s66, s66, 156160
    v_add_u32 v189, s66, v14
    v_mov_b32 v193, 0x40000000
    v_mov_b32 v194, 0x40000000
    v_add_u32 v4, 0, v1
    v_add_u32 v5, 64, v1
    v_add_u32 v6, 128, v1
    v_add_u32 v7, 192, v1
    v_add_u32 v8, 256, v1
    v_mul_u32_u24 v245, 6554, v4
    v_mul_u32_u24 v246, 6554, v5
    v_mul_u32_u24 v247, 6554, v6
    v_mul_u32_u24 v248, 6554, v7
    v_mul_u32_u24 v249, 6554, v8
    v_lshrrev_b32 v245, 16, v245
    v_lshrrev_b32 v246, 16, v246
    v_lshrrev_b32 v247, 16, v247
    v_lshrrev_b32 v248, 16, v248
    v_lshrrev_b32 v249, 16, v249
    v_mul_u32_u24 v245, 1120, v245
    v_mul_u32_u24 v246, 1120, v246
    v_mul_u32_u24 v247, 1120, v247
    v_mul_u32_u24 v248, 1120, v248
    v_mul_u32_u24 v249, 1120, v249
    v_lshl_add_u32 v245, v4, 4, v245
    v_lshl_add_u32 v246, v5, 4, v246
    v_lshl_add_u32 v247, v6, 4, v247
    v_lshl_add_u32 v248, v7, 4, v248
    v_lshl_add_u32 v249, v8, 4, v249
    v_subrev_u32 v246, 1024, v246
    v_subrev_u32 v247, 2048, v247
    v_subrev_u32 v248, 3072, v248
    s_barrier
L_ZL2:
    s_add_u32 m0, s49, 0
    s_nop 0
    buffer_load_dwordx4 v236, s[8:11], s50 offen offset:0 lds
    buffer_load_dwordx4 v237, s[8:11], s50 offen offset:1024 lds
    buffer_load_dwordx4 v238, s[8:11], s50 offen offset:2048 lds
    buffer_load_dwordx4 v239, s[8:11], s50 offen offset:3072 lds
    s_add_u32 m0, m0, s53
    s_nop 0
    buffer_load_dwordx4 v240, s[12:15], s51 offen offset:0 lds
    buffer_load_dwordx4 v241, s[12:15], s51 offen offset:1024 lds
    buffer_load_dwordx4 v242, s[12:15], s51 offen offset:2048 lds
    s_add_u32 s52, s52, 1
    s_cmp_eq_u32 s52, 10
    s_cselect_b32 s66, 1280, 0
    s_sub_u32 s50, s50, s66
    s_cmp_eq_u32 s52, 10
    s_cselect_b32 s66, 2457600, 0
    s_sub_u32 s51, s51, s66
    s_add_u32 m0, s49, 28672
    s_add_u32 s50, s50, 128
    buffer_load_dwordx4 v236, s[8:11], s50 offen offset:0 lds
    buffer_load_dwordx4 v237, s[8:11], s50 offen offset:1024 lds
    buffer_load_dwordx4 v238, s[8:11], s50 offen offset:2048 lds
    buffer_load_dwordx4 v239, s[8:11], s50 offen offset:3072 lds
    s_add_u32 m0, m0, s53
    s_add_u32 s51, s51, 245760
    buffer_load_dwordx4 v240, s[12:15], s51 offen offset:0 lds
    buffer_load_dwordx4 v241, s[12:15], s51 offen offset:1024 lds
    buffer_load_dwordx4 v242, s[12:15], s51 offen offset:2048 lds
    v_lshrrev_b32 v2, 5, v1
    v_bfe_u32 v3, v1, 4, 1
    v_and_b32 v9, 15, v1
    v_lshlrev_b32 v4, 10, v2
    v_lshl_add_u32 v4, v3, 9, v4
    v_lshl_add_u32 v209, v9, 4, v4
    v_mul_u32_u24 v5, 5120, v2
    v_lshl_add_u32 v5, v3, 8, v5
    v_lshl_add_u32 v210, v9, 3, v5
    v_bfe_u32 v10, v1, 2, 2
    v_and_b32 v11, 3, v1
    v_mul_u32_u24 v12, 20, v3
    v_add_u32 v12, v12, v10
    v_lshl_add_u32 v6, v2, 3, v12
    v_mul_u32_u24 v6, 160, v6
    v_lshl_add_u32 v6, v11, 3, v6
    v_mul_u32_u24 v7, 80, v2
    v_add3_u32 v7, v7, v12, 16
    v_mul_u32_u24 v7, 160, v7
    v_lshl_add_u32 v7, v11, 3, v7
    s_mul_i32 s66, s62, 51200
    s_add_u32 s66, s66, 36864
    v_add_u32 v211, s66, v6
    v_add_u32 v212, s66, v7
    s_and_b32 s66, s45, 3
    s_lshl2_add_u32 s66, s44, s66
    s_lshr_b32 s3, s66, 1
    s_bfe_u32 s68, s45, 0x20002
    s_lshl2_add_u32 s3, s3, s68
    s_lshl_b32 s3, s3, 8
    s_add_u32 s3, s3, 147456
    s_lshr_b32 s68, s47, 1
    s_lshl1_add_u32 s67, s66, s68
    s_lshl1_add_u32 s67, s67, s62
    s_mul_i32 s67, s67, 20480
    s_add_u32 s67, s67, 524288
    s_and_b32 s68, s47, 1
    s_lshl_b32 s69, s68, 7
    s_add_u32 s69, s69, s67
    s_add_u32 s4, s69, 4096
    s_lshl_b32 s68, s68, 8
    s_add_u32 s5, s67, s68
    s_lshl2_add_u32 s66, s66, s47
    s_mul_i32 s66, s66, 40960
    s_lshr_b32 s68, s45, 2
    s_mul_i32 s68, s68, 160
    s_add_u32 s6, s66, s68
    v_mul_u32_u24 v8, 2560, v9
    v_lshrrev_b32 v2, 4, v1
    v_lshl_add_u32 v213, v2, 3, v8
    v_lshrrev_b32 v2, 5, v1
    v_lshl_add_u32 v8, v3, 5, v8
    v_lshl_add_u32 v215, v2, 4, v8
    s_mul_i32 s66, s47, 5120
    s_add_u32 s66, s66, 0
    v_lshl_add_u32 v214, v1, 4, s66
    v_mul_u32_u24 v3, 6554, v0
    v_lshrrev_b32 v3, 16, v3
    v_lshlrev_b32 v6, 5, v3
    v_lshl_add_u32 v6, v0, 4, v6
    v_cmp_gt_u32 vcc, 440, v0
    v_mov_b32 v15, 0x40000000
    v_mul_u32_u24 v8, 80, v3
    v_cndmask_b32 v6, v15, v6, vcc
    v_lshl_add_u32 v8, v0, 3, v8
    v_add_u32 v8, 155136, v8
    v_mov_b32 v7, 0xffff0000
    v_bfe_u32 v9, v1, 2, 1
    v_bfe_u32 v10, v1, 3, 2
    v_and_b32 v11, 3, v1
    v_lshl_add_u32 v10, v10, 2, v11
    v_add_u32 v11, 16, v10
    v_min_u32 v11, 20, v11
    v_mul_u32_u24 v12, 22, v9
    s_mul_i32 s66, s62, 44
    v_add_u32 v12, s66, v12
    v_add_u32 v10, v10, v12
    v_add_u32 v11, v11, v12
    v_mul_u32_u24 v10, 80, v10
    v_mul_u32_u24 v11, 80, v11
    v_lshrrev_b32 v12, 5, v1
    v_cmp_eq_u32 vcc, v12, v9
    v_mov_b32 v13, 7040
    s_mul_i32 s67, s42, 8448
    v_cndmask_b32 v10, v13, v10, vcc
    v_cndmask_b32 v11, v13, v11, vcc
    v_add_u32 v10, 155136, v10
    v_add_u32 v11, 155136, v11
    s_lshl_b32 s68, s41, 2
    s_add_u32 s68, s68, s47
    s_lshl_b32 s68, s68, 3
    s_add_u32 s68, s68, s42
    s_mul_i32 s68, s68, 5120
    s_add_u32 s68, s68, 524288
    s_lshl_b32 s69, s62, 9
    s_add_u32 s69, s69, s68
    s_add_u32 s69, s69, 4096
    s_lshl_b32 s70, s62, 11
    s_add_u32 s68, s68, s70
    v_lshlrev_b32 v12, 4, v1
    v_lshlrev_b32 v13, 3, v1
    v_mov_b32 v199, v6
    v_mov_b32 v200, v7
    v_mov_b32 v201, v8
    v_mov_b32 v202, v10
    v_mov_b32 v203, v11
    v_mov_b32 v204, v12
    v_mov_b32 v205, v13
    s_mov_b32 s7, s67
    s_mov_b32 s46, s68
    s_mov_b32 s54, s69
    s_waitcnt vmcnt(7)
    s_barrier
    s_add_u32 s52, s52, 1
    s_cmp_eq_u32 s52, 10
    s_cselect_b32 s66, 1280, 0
    s_sub_u32 s50, s50, s66
    s_cmp_eq_u32 s52, 10
    s_cselect_b32 s66, 2457600, 0
    s_sub_u32 s51, s51, s66
    s_add_u32 m0, s49, 57344
    s_add_u32 s50, s50, 128
    buffer_load_dwordx4 v236, s[8:11], s50 offen offset:0 lds
    buffer_load_dwordx4 v237, s[8:11], s50 offen offset:1024 lds
    buffer_load_dwordx4 v238, s[8:11], s50 offen offset:2048 lds
    buffer_load_dwordx4 v239, s[8:11], s50 offen offset:3072 lds
    s_add_u32 m0, m0, s53
    s_add_u32 s51, s51, 245760
    buffer_load_dwordx4 v240, s[12:15], s51 offen offset:0 lds
    buffer_load_dwordx4 v241, s[12:15], s51 offen offset:1024 lds
    buffer_load_dwordx4 v242, s[12:15], s51 offen offset:2048 lds
    s_waitcnt vmcnt(7)
    s_barrier
    s_add_u32 s52, s52, 1
    s_cmp_eq_u32 s52, 10
    s_cselect_b32 s66, 1280, 0
    s_sub_u32 s50, s50, s66
    s_cmp_eq_u32 s52, 10
    s_cselect_b32 s66, 2457600, 0
    s_sub_u32 s51, s51, s66
    s_add_u32 m0, s49, 0
    s_add_u32 s50, s50, 128
    buffer_load_dwordx4 v236, s[8:11], s50 offen offset:0 lds
    buffer_load_dwordx4 v237, s[8:11], s50 offen offset:1024 lds
    buffer_load_dwordx4 v238, s[8:11], s50 offen offset:2048 lds
    buffer_load_dwordx4 v239, s[8:11], s50 offen offset:3072 lds
    s_add_u32 m0, m0, s53
    s_add_u32 s51, s51, 245760
    buffer_load_dwordx4 v240, s[12:15], s51 offen offset:0 lds
    buffer_load_dwordx4 v241, s[12:15], s51 offen offset:1024 lds
    buffer_load_dwordx4 v242, s[12:15], s51 offen offset:2048 lds
    s_waitcnt vmcnt(7)
    s_barrier
    s_add_u32 s52, s52, 1
    s_cmp_eq_u32 s52, 10
    s_cselect_b32 s66, 1280, 0
    s_sub_u32 s50, s50, s66
    s_cmp_eq_u32 s52, 10
    s_cselect_b32 s66, 2457600, 0
    s_sub_u32 s51, s51, s66
    s_add_u32 m0, s49, 28672
    s_add_u32 s50, s50, 128
    buffer_load_dwordx4 v236, s[8:11], s50 offen offset:0 lds
    buffer_load_dwordx4 v237, s[8:11], s50 offen offset:1024 lds
    buffer_load_dwordx4 v238, s[8:11], s50 offen offset:2048 lds
    buffer_load_dwordx4 v239, s[8:11], s50 offen offset:3072 lds
    s_add_u32 m0, m0, s53
    s_add_u32 s51, s51, 245760
    buffer_load_dwordx4 v240, s[12:15], s51 offen offset:0 lds
    buffer_load_dwordx4 v241, s[12:15], s51 offen offset:1024 lds
    buffer_load_dwordx4 v242, s[12:15], s51 offen offset:2048 lds
    s_waitcnt vmcnt(7)
    s_barrier
    s_add_u32 s52, s52, 1
    s_cmp_eq_u32 s52, 10
    s_cselect_b32 s66, 1280, 0
    s_sub_u32 s50, s50, s66
    s_cmp_eq_u32 s52, 10
    s_cselect_b32 s66, 2457600, 0
    s_sub_u32 s51, s51, s66
    s_add_u32 m0, s49, 57344
    s_add_u32 s50, s50, 128
    buffer_load_dwordx4 v236, s[8:11], s50 offen offset:0 lds
    buffer_load_dwordx4 v237, s[8:11], s50 offen offset:1024 lds
    buffer_load_dwordx4 v238, s[8:11], s50 offen offset:2048 lds
    buffer_load_dwordx4 v239, s[8:11], s50 offen offset:3072 lds
    s_add_u32 m0, m0, s53
    s_add_u32 s51, s51, 245760
    buffer_load_dwordx4 v240, s[12:15], s51 offen offset:0 lds
    buffer_load_dwordx4 v241, s[12:15], s51 offen offset:1024 lds
    buffer_load_dwordx4 v242, s[12:15], s51 offen offset:2048 lds
    s_waitcnt vmcnt(7)
    s_barrier
    s_add_u32 s52, s52, 1
    s_cmp_eq_u32 s52, 10
    s_cselect_b32 s66, 1280, 0
    s_sub_u32 s50, s50, s66
    s_cmp_eq_u32 s52, 10
    s_cselect_b32 s66, 2457600, 0
    s_sub_u32 s51, s51, s66
    s_add_u32 m0, s49, 0
    s_add_u32 s50, s50, 128
    buffer_load_dwordx4 v236, s[8:11], s50 offen offset:0 lds
    buffer_load_dwordx4 v237, s[8:11], s50 offen offset:1024 lds
    buffer_load_dwordx4 v238, s[8:11], s50 offen offset:2048 lds
    buffer_load_dwordx4 v239, s[8:11], s50 offen offset:3072 lds
    s_add_u32 m0, m0, s53
    s_add_u32 s51, s51, 245760
    buffer_load_dwordx4 v240, s[12:15], s51 offen offset:0 lds
    buffer_load_dwordx4 v241, s[12:15], s51 offen offset:1024 lds
    buffer_load_dwordx4 v242, s[12:15], s51 offen offset:2048 lds
    s_waitcnt vmcnt(7)
    s_barrier
    s_add_u32 s52, s52, 1
    s_cmp_eq_u32 s52, 10
    s_cselect_b32 s66, 1280, 0
    s_sub_u32 s50, s50, s66
    s_cmp_eq_u32 s52, 10
    s_cselect_b32 s66, 2457600, 0
    s_sub_u32 s51, s51, s66
    s_add_u32 m0, s49, 28672
    s_add_u32 s50, s50, 128
    buffer_load_dwordx4 v236, s[8:11], s50 offen offset:0 lds
    buffer_load_dwordx4 v237, s[8:11], s50 offen offset:1024 lds
    buffer_load_dwordx4 v238, s[8:11], s50 offen offset:2048 lds
    buffer_load_dwordx4 v239, s[8:11], s50 offen offset:3072 lds
    s_add_u32 m0, m0, s53
    s_add_u32 s51, s51, 245760
    buffer_load_dwordx4 v240, s[12:15], s51 offen offset:0 lds
    buffer_load_dwordx4 v241, s[12:15], s51 offen offset:1024 lds
    buffer_load_dwordx4 v242, s[12:15], s51 offen offset:2048 lds
    s_waitcnt vmcnt(7)
    s_barrier
    s_add_u32 s52, s52, 1
    s_cmp_eq_u32 s52, 10
    s_cselect_b32 s66, 1280, 0
    s_sub_u32 s50, s50, s66
    s_cmp_eq_u32 s52, 10
    s_cselect_b32 s66, 2457600, 0
    s_sub_u32 s51, s51, s66
    s_add_u32 m0, s49, 57344
    s_add_u32 s50, s50, 128
    buffer_load_dwordx4 v236, s[8:11], s50 offen offset:0 lds
    buffer_load_dwordx4 v237, s[8:11], s50 offen offset:1024 lds
    buffer_load_dwordx4 v238, s[8:11], s50 offen offset:2048 lds
    buffer_load_dwordx4 v239, s[8:11], s50 offen offset:3072 lds
    s_add_u32 m0, m0, s53
    s_add_u32 s51, s51, 245760
    buffer_load_dwordx4 v240, s[12:15], s51 offen offset:0 lds
    buffer_load_dwordx4 v241, s[12:15], s51 offen offset:1024 lds
    buffer_load_dwordx4 v242, s[12:15], s51 offen offset:2048 lds
    s_waitcnt vmcnt(7)
    s_barrier
    s_add_u32 s52, s52, 1
    s_cmp_eq_u32 s52, 10
    s_cselect_b32 s66, 1280, 0
    s_sub_u32 s50, s50, s66
    s_cmp_eq_u32 s52, 10
    s_cselect_b32 s66, 2457600, 0
    s_sub_u32 s51, s51, s66
    s_add_u32 m0, s49, 0
    s_add_u32 s50, s50, 128
    buffer_load_dwordx4 v236, s[8:11], s50 offen offset:0 lds
    buffer_load_dwordx4 v237, s[8:11], s50 offen offset:1024 lds
    buffer_load_dwordx4 v238, s[8:11], s50 offen offset:2048 lds
    buffer_load_dwordx4 v239, s[8:11], s50 offen offset:3072 lds
    s_add_u32 m0, m0, s53
    s_add_u32 s51, s51, 245760
    buffer_load_dwordx4 v240, s[12:15], s51 offen offset:0 lds
    buffer_load_dwordx4 v241, s[12:15], s51 offen offset:1024 lds
    buffer_load_dwordx4 v242, s[12:15], s51 offen offset:2048 lds
    s_waitcnt vmcnt(7)
    s_barrier
    s_lshr_b32 s58, s45, 2
    s_mul_i32 s58, s58, 160
    s_mul_i32 s59, s47, 40960
    s_add_u32 s58, s58, s59
    s_add_u32 s58, s58, 491520
    s_mul_i32 s59, s47, 5120
    s_add_u32 m0, s59, 98304
    s_nop 0
    buffer_load_dwordx4 v245, s[20:23], s58 offen offset:0 lds
    buffer_load_dwordx4 v246, s[20:23], s58 offen offset:1024 lds
    buffer_load_dwordx4 v247, s[20:23], s58 offen offset:2048 lds
    buffer_load_dwordx4 v248, s[20:23], s58 offen offset:3072 lds
    s_add_u32 m0, m0, 4096
    s_nop 0
    buffer_load_dwordx4 v249, s[20:23], s58 offen lds
    s_add_u32 m0, m0, 16384
    s_add_u32 s58, s58, 163840
    buffer_load_dwordx4 v245, s[20:23], s58 offen offset:0 lds
    buffer_load_dwordx4 v246, s[20:23], s58 offen offset:1024 lds
    buffer_load_dwordx4 v247, s[20:23], s58 offen offset:2048 lds
    buffer_load_dwordx4 v248, s[20:23], s58 offen offset:3072 lds
    s_add_u32 m0, m0, 4096
    s_nop 0
    buffer_load_dwordx4 v249, s[20:23], s58 offen lds
WOGE_36:
    s_waitcnt vmcnt(10) lgkmcnt(0)
    s_barrier
    s_lshl2_add_u32 s66, s43, s47
    s_mul_i32 s67, s66, 205
    s_lshr_b32 s67, s67, 10
    s_mul_i32 s68, s67, 81280
    s_lshl_b32 s66, s66, 7
    s_add_u32 s66, s66, s68
    v_mul_u32_u24 v250, 1280, v1
    buffer_load_dword v251, v250, s[20:23], s66 offen offset:0
    ds_read_b64_tr_b16 v[164:165], v189 offset:0
    ds_read_b64_tr_b16 v[166:167], v189 offset:320
    ds_read_b64_tr_b16 v[168:169], v189 offset:1280
    ds_read_b64_tr_b16 v[170:171], v189 offset:1600
    ds_read_b64_tr_b16 v[172:173], v189 offset:2560
    ds_read_b64_tr_b16 v[174:175], v189 offset:2880
    ds_read_b64_tr_b16 v[176:177], v189 offset:64
    ds_read_b64_tr_b16 v[178:179], v189 offset:384
    ds_read_b64_tr_b16 v[180:181], v189 offset:1344
    ds_read_b64_tr_b16 v[182:183], v189 offset:1664
    ds_read_b64_tr_b16 v[184:185], v189 offset:2624
    ds_read_b64_tr_b16 v[186:187], v189 offset:2944
    s_waitcnt lgkmcnt(0)
    s_branch L_PHI
L_QB_CP:
    s_lshl2_add_u32 s66, s42, s47
    s_mul_i32 s66, s66, 800
    v_lshlrev_b32 v2, 3, v1
    v_add_u32 v3, 512, v2
    v_cmp_gt_u32 vcc, 36, v1
    v_mov_b32 v9, 0x40000000
    buffer_load_dwordx2 v[224:225], v2, s[16:19], s66 offen
    v_cndmask_b32 v3, v9, v3, vcc
    buffer_load_dwordx2 v[228:229], v3, s[16:19], s66 offen
    s_cmp_ge_u32 s2, 208
    s_cbranch_scc0 L_NOZ
    v_mov_b32 v4, 0
    v_mov_b32 v5, 0
    v_mov_b32 v6, 0
    v_mov_b32 v7, 0
    v_lshlrev_b32 v2, 4, v0
    s_sub_u32 s66, s2, 208
    s_lshl_b32 s66, s66, 12
    buffer_store_dwordx4 v[4:7], v2, s[36:39], s66 offen sc1
    s_waitcnt vmcnt(0)
    s_barrier
    s_cmp_eq_u32 s40, 0
    s_cbranch_scc0 L_NOISIG
    v_mov_b32 v2, 0
    v_mov_b32 v3, 1
    s_mov_b64 s[64:65], exec
    s_mov_b64 exec, 1
    buffer_atomic_add v3, v2, s[32:35], 0 offen
    s_mov_b64 exec, s[64:65]
L_NOISIG:
    s_branch L_QSET
L_NOZ:
    s_sub_u32 s66, s2, 128
    s_mul_i32 s67, s66, 205
    s_lshr_b32 s67, s67, 10
    s_mul_i32 s68, s67, 5
    s_sub_u32 s68, s66, s68
    v_bfe_u32 v2, v1, 1, 4
    s_lshl_b32 s69, s47, 4
    v_add_u32 v2, s69, v2
    v_and_b32 v3, 1, v1
    v_mul_u32_u24 v9, s67, v2
    v_lshl_add_u32 v9, v3, 9, v9
    v_lshl_add_u32 v10, v2, 1, v3
    v_cmp_eq_u32 vcc, 1, v10
    v_mov_b32 v11, 64
    v_lshrrev_b32 v12, 5, v1
    v_cndmask_b32 v2, v2, v11, vcc
    v_cndmask_b32 v9, v9, 0, vcc
    v_lshlrev_b32 v12, 7, v12
    v_mul_u32_u24 v12, v2, v12
    v_add_u32 v9, v9, v12
    v_and_b32 v9, 2047, v9
    v_cvt_f32_u32 v9, v9
    v_cvt_f32_u32 v2, v2
    v_mul_f32 v48, 0x3a000000, v9
    v_mul_f32 v2, 0x3c000000, v2
    v_mul_f32 v3, 0x41800000, v2
    v_add_f32 v49, v48, v2
    v_add_f32 v50, v49, v2
    v_add_f32 v51, v50, v2
    v_add_f32 v52, v51, v2
    v_add_f32 v53, v52, v2
    v_add_f32 v54, v53, v2
    v_add_f32 v55, v54, v2
    v_cos_f32 v4, v3
    v_add_f32 v56, v48, v3
    v_add_f32 v57, v49, v3
    v_add_f32 v58, v50, v3
    v_add_f32 v59, v51, v3
    v_add_f32 v60, v52, v3
    v_add_f32 v61, v53, v3
    v_add_f32 v62, v54, v3
    v_add_f32 v63, v55, v3
    v_add_f32 v4, v4, v4
    v_mov_b32 v5, v4
    v_cos_f32 v48, v48
    v_cos_f32 v49, v49
    v_cos_f32 v50, v50
    v_cos_f32 v51, v51
    v_cos_f32 v52, v52
    v_cos_f32 v53, v53
    v_cos_f32 v54, v54
    v_cos_f32 v55, v55
    v_cos_f32 v56, v56
    v_cos_f32 v57, v57
    v_cos_f32 v58, v58
    v_cos_f32 v59, v59
    v_cos_f32 v60, v60
    v_cos_f32 v61, v61
    v_cos_f32 v62, v62
    v_cos_f32 v63, v63
    v_cvt_pk_bf16_f32 v16, v48, v49
    v_cvt_pk_bf16_f32 v17, v50, v51
    v_cvt_pk_bf16_f32 v18, v52, v53
    v_cvt_pk_bf16_f32 v19, v54, v55
    v_cvt_pk_bf16_f32 v20, v56, v57
    v_cvt_pk_bf16_f32 v21, v58, v59
    v_cvt_pk_bf16_f32 v22, v60, v61
    v_cvt_pk_bf16_f32 v23, v62, v63
    v_pk_fma_f32 v[48:49], v[4:5], v[56:57], v[48:49] neg_lo:[0,0,1] neg_hi:[0,0,1]
    v_pk_fma_f32 v[50:51], v[4:5], v[58:59], v[50:51] neg_lo:[0,0,1] neg_hi:[0,0,1]
    v_pk_fma_f32 v[52:53], v[4:5], v[60:61], v[52:53] neg_lo:[0,0,1] neg_hi:[0,0,1]
    v_pk_fma_f32 v[54:55], v[4:5], v[62:63], v[54:55] neg_lo:[0,0,1] neg_hi:[0,0,1]
    v_cvt_pk_bf16_f32 v24, v48, v49
    v_cvt_pk_bf16_f32 v25, v50, v51
    v_cvt_pk_bf16_f32 v26, v52, v53
    v_cvt_pk_bf16_f32 v27, v54, v55
    v_pk_fma_f32 v[56:57], v[4:5], v[48:49], v[56:57] neg_lo:[0,0,1] neg_hi:[0,0,1]
    v_pk_fma_f32 v[58:59], v[4:5], v[50:51], v[58:59] neg_lo:[0,0,1] neg_hi:[0,0,1]
    v_pk_fma_f32 v[60:61], v[4:5], v[52:53], v[60:61] neg_lo:[0,0,1] neg_hi:[0,0,1]
    v_pk_fma_f32 v[62:63], v[4:5], v[54:55], v[62:63] neg_lo:[0,0,1] neg_hi:[0,0,1]
    v_cvt_pk_bf16_f32 v28, v56, v57
    v_cvt_pk_bf16_f32 v29, v58, v59
    v_cvt_pk_bf16_f32 v30, v60, v61
    v_cvt_pk_bf16_f32 v31, v62, v63
    v_pk_fma_f32 v[48:49], v[4:5], v[56:57], v[48:49] neg_lo:[0,0,1] neg_hi:[0,0,1]
    v_pk_fma_f32 v[50:51], v[4:5], v[58:59], v[50:51] neg_lo:[0,0,1] neg_hi:[0,0,1]
    v_pk_fma_f32 v[52:53], v[4:5], v[60:61], v[52:53] neg_lo:[0,0,1] neg_hi:[0,0,1]
    v_pk_fma_f32 v[54:55], v[4:5], v[62:63], v[54:55] neg_lo:[0,0,1] neg_hi:[0,0,1]
    v_cvt_pk_bf16_f32 v32, v48, v49
    v_cvt_pk_bf16_f32 v33, v50, v51
    v_cvt_pk_bf16_f32 v34, v52, v53
    v_cvt_pk_bf16_f32 v35, v54, v55
    v_pk_fma_f32 v[56:57], v[4:5], v[48:49], v[56:57] neg_lo:[0,0,1] neg_hi:[0,0,1]
    v_pk_fma_f32 v[58:59], v[4:5], v[50:51], v[58:59] neg_lo:[0,0,1] neg_hi:[0,0,1]
    v_pk_fma_f32 v[60:61], v[4:5], v[52:53], v[60:61] neg_lo:[0,0,1] neg_hi:[0,0,1]
    v_pk_fma_f32 v[62:63], v[4:5], v[54:55], v[62:63] neg_lo:[0,0,1] neg_hi:[0,0,1]
    v_cvt_pk_bf16_f32 v36, v56, v57
    v_cvt_pk_bf16_f32 v37, v58, v59
    v_cvt_pk_bf16_f32 v38, v60, v61
    v_cvt_pk_bf16_f32 v39, v62, v63
    v_pk_fma_f32 v[48:49], v[4:5], v[56:57], v[48:49] neg_lo:[0,0,1] neg_hi:[0,0,1]
    v_pk_fma_f32 v[50:51], v[4:5], v[58:59], v[50:51] neg_lo:[0,0,1] neg_hi:[0,0,1]
    v_pk_fma_f32 v[52:53], v[4:5], v[60:61], v[52:53] neg_lo:[0,0,1] neg_hi:[0,0,1]
    v_pk_fma_f32 v[54:55], v[4:5], v[62:63], v[54:55] neg_lo:[0,0,1] neg_hi:[0,0,1]
    v_cvt_pk_bf16_f32 v40, v48, v49
    v_cvt_pk_bf16_f32 v41, v50, v51
    v_cvt_pk_bf16_f32 v42, v52, v53
    v_cvt_pk_bf16_f32 v43, v54, v55
    v_pk_fma_f32 v[56:57], v[4:5], v[48:49], v[56:57] neg_lo:[0,0,1] neg_hi:[0,0,1]
    v_pk_fma_f32 v[58:59], v[4:5], v[50:51], v[58:59] neg_lo:[0,0,1] neg_hi:[0,0,1]
    v_pk_fma_f32 v[60:61], v[4:5], v[52:53], v[60:61] neg_lo:[0,0,1] neg_hi:[0,0,1]
    v_pk_fma_f32 v[62:63], v[4:5], v[54:55], v[62:63] neg_lo:[0,0,1] neg_hi:[0,0,1]
    v_cvt_pk_bf16_f32 v44, v56, v57
    v_cvt_pk_bf16_f32 v45, v58, v59
    v_cvt_pk_bf16_f32 v46, v60, v61
    v_cvt_pk_bf16_f32 v47, v62, v63
    v_bfe_u32 v10, v1, 4, 1
    v_bfe_u32 v11, v1, 2, 2
    v_and_b32 v12, 3, v1
    v_lshrrev_b32 v9, 5, v1
    v_lshl_add_u32 v13, v9, 3, v11
    v_lshlrev_b32 v13, 8, v13
    v_lshl_add_u32 v13, v10, 5, v13
    v_lshl_add_u32 v13, v12, 3, v13
    v_lshl_add_u32 v13, v11, 6, v13
    v_add_u32 v4, 114688, v13
    v_xor_b32 v5, 64, v13
    v_add_u32 v5, 114688, v5
    v_xor_b32 v6, 128, v13
    v_add_u32 v6, 114688, v6
    v_xor_b32 v7, 192, v13
    v_add_u32 v7, 114688, v7
    v_and_b32 v2, 31, v1
    v_lshlrev_b32 v8, 2, v2
    v_lshl_add_u32 v8, v9, 10, v8
    s_lshl_b32 s69, s47, 13
    s_add_u32 s69, s69, 57344
    v_add_u32 v8, s69, v8
    s_barrier
    ds_read_b64_tr_b16 v[112:113], v4 offset:0
    ds_read_b64_tr_b16 v[114:115], v4 offset:1024
    ds_read_b64_tr_b16 v[116:117], v4 offset:4096
    ds_read_b64_tr_b16 v[118:119], v4 offset:5120
    ds_read_b64_tr_b16 v[120:121], v4 offset:8192
    ds_read_b64_tr_b16 v[122:123], v4 offset:9216
    ds_read_b64_tr_b16 v[124:125], v4 offset:12288
    ds_read_b64_tr_b16 v[126:127], v4 offset:13312
    ds_read_b64_tr_b16 v[128:129], v4 offset:16384
    ds_read_b64_tr_b16 v[130:131], v4 offset:17408
    ds_read_b64_tr_b16 v[132:133], v4 offset:20480
    ds_read_b64_tr_b16 v[134:135], v4 offset:21504
    s_waitcnt lgkmcnt(10)
    v_mfma_f32_32x32x16_bf16 v[48:63], v[16:19], v[112:115], 0
    ds_read_b64_tr_b16 v[136:137], v4 offset:24576
    ds_read_b64_tr_b16 v[138:139], v4 offset:25600
    s_waitcnt lgkmcnt(10)
    v_mfma_f32_32x32x16_bf16 v[48:63], v[20:23], v[116:119], v[48:63]
    ds_read_b64_tr_b16 v[140:141], v4 offset:28672
    ds_read_b64_tr_b16 v[142:143], v4 offset:29696
    s_waitcnt lgkmcnt(10)
    v_mfma_f32_32x32x16_bf16 v[48:63], v[24:27], v[120:123], v[48:63]
    ds_read_b64_tr_b16 v[112:113], v5 offset:0
    ds_read_b64_tr_b16 v[114:115], v5 offset:1024
    s_waitcnt lgkmcnt(10)
    v_mfma_f32_32x32x16_bf16 v[48:63], v[28:31], v[124:127], v[48:63]
    ds_read_b64_tr_b16 v[116:117], v5 offset:4096
    ds_read_b64_tr_b16 v[118:119], v5 offset:5120
    s_waitcnt lgkmcnt(10)
    v_mfma_f32_32x32x16_bf16 v[48:63], v[32:35], v[128:131], v[48:63]
    ds_read_b64_tr_b16 v[120:121], v5 offset:8192
    ds_read_b64_tr_b16 v[122:123], v5 offset:9216
    s_waitcnt lgkmcnt(10)
    v_mfma_f32_32x32x16_bf16 v[48:63], v[36:39], v[132:135], v[48:63]
    ds_read_b64_tr_b16 v[124:125], v5 offset:12288
    ds_read_b64_tr_b16 v[126:127], v5 offset:13312
    s_waitcnt lgkmcnt(10)
    v_mfma_f32_32x32x16_bf16 v[48:63], v[40:43], v[136:139], v[48:63]
    ds_read_b64_tr_b16 v[128:129], v5 offset:16384
    ds_read_b64_tr_b16 v[130:131], v5 offset:17408
    s_waitcnt lgkmcnt(10)
    v_mfma_f32_32x32x16_bf16 v[48:63], v[44:47], v[140:143], v[48:63]
    ds_read_b64_tr_b16 v[132:133], v5 offset:20480
    ds_read_b64_tr_b16 v[134:135], v5 offset:21504
    s_waitcnt lgkmcnt(10)
    v_mfma_f32_32x32x16_bf16 v[64:79], v[16:19], v[112:115], 0
    ds_read_b64_tr_b16 v[136:137], v5 offset:24576
    ds_read_b64_tr_b16 v[138:139], v5 offset:25600
    s_waitcnt lgkmcnt(10)
    v_mfma_f32_32x32x16_bf16 v[64:79], v[20:23], v[116:119], v[64:79]
    ds_read_b64_tr_b16 v[140:141], v5 offset:28672
    ds_read_b64_tr_b16 v[142:143], v5 offset:29696
    s_waitcnt lgkmcnt(10)
    v_mfma_f32_32x32x16_bf16 v[64:79], v[24:27], v[120:123], v[64:79]
    ds_read_b64_tr_b16 v[112:113], v6 offset:0
    ds_read_b64_tr_b16 v[114:115], v6 offset:1024
    s_waitcnt lgkmcnt(10)
    v_mfma_f32_32x32x16_bf16 v[64:79], v[28:31], v[124:127], v[64:79]
    ds_read_b64_tr_b16 v[116:117], v6 offset:4096
    ds_read_b64_tr_b16 v[118:119], v6 offset:5120
    v_cvt_pk_bf16_f32 v200, v48, v49
    ds_write_b32 v8, v200 offset:0
    s_waitcnt lgkmcnt(11)
    v_mfma_f32_32x32x16_bf16 v[64:79], v[32:35], v[128:131], v[64:79]
    ds_read_b64_tr_b16 v[120:121], v6 offset:8192
    ds_read_b64_tr_b16 v[122:123], v6 offset:9216
    v_cvt_pk_bf16_f32 v201, v50, v51
    ds_write_b32 v8, v201 offset:512
    s_waitcnt lgkmcnt(12)
    v_mfma_f32_32x32x16_bf16 v[64:79], v[36:39], v[132:135], v[64:79]
    ds_read_b64_tr_b16 v[124:125], v6 offset:12288
    ds_read_b64_tr_b16 v[126:127], v6 offset:13312
    v_cvt_pk_bf16_f32 v202, v52, v53
    ds_write_b32 v8, v202 offset:2048
    s_waitcnt lgkmcnt(13)
    v_mfma_f32_32x32x16_bf16 v[64:79], v[40:43], v[136:139], v[64:79]
    ds_read_b64_tr_b16 v[128:129], v6 offset:16384
    ds_read_b64_tr_b16 v[130:131], v6 offset:17408
    v_cvt_pk_bf16_f32 v203, v54, v55
    ds_write_b32 v8, v203 offset:2560
    s_waitcnt lgkmcnt(14)
    v_mfma_f32_32x32x16_bf16 v[64:79], v[44:47], v[140:143], v[64:79]
    ds_read_b64_tr_b16 v[132:133], v6 offset:20480
    ds_read_b64_tr_b16 v[134:135], v6 offset:21504
    v_cvt_pk_bf16_f32 v204, v56, v57
    ds_write_b32 v8, v204 offset:4096
    s_waitcnt lgkmcnt(15)
    v_mfma_f32_32x32x16_bf16 v[80:95], v[16:19], v[112:115], 0
    ds_read_b64_tr_b16 v[136:137], v6 offset:24576
    ds_read_b64_tr_b16 v[138:139], v6 offset:25600
    v_cvt_pk_bf16_f32 v205, v58, v59
    ds_write_b32 v8, v205 offset:4608
    s_waitcnt lgkmcnt(15)
    v_mfma_f32_32x32x16_bf16 v[80:95], v[20:23], v[116:119], v[80:95]
    ds_read_b64_tr_b16 v[140:141], v6 offset:28672
    ds_read_b64_tr_b16 v[142:143], v6 offset:29696
    v_cvt_pk_bf16_f32 v206, v60, v61
    ds_write_b32 v8, v206 offset:6144
    s_waitcnt lgkmcnt(15)
    v_mfma_f32_32x32x16_bf16 v[80:95], v[24:27], v[120:123], v[80:95]
    ds_read_b64_tr_b16 v[112:113], v7 offset:0
    ds_read_b64_tr_b16 v[114:115], v7 offset:1024
    v_cvt_pk_bf16_f32 v207, v62, v63
    ds_write_b32 v8, v207 offset:6656
    s_waitcnt lgkmcnt(15)
    v_mfma_f32_32x32x16_bf16 v[80:95], v[28:31], v[124:127], v[80:95]
    ds_read_b64_tr_b16 v[116:117], v7 offset:4096
    ds_read_b64_tr_b16 v[118:119], v7 offset:5120
    v_cvt_pk_bf16_f32 v200, v64, v65
    ds_write_b32 v8, v200 offset:128
    s_waitcnt lgkmcnt(15)
    v_mfma_f32_32x32x16_bf16 v[80:95], v[32:35], v[128:131], v[80:95]
    ds_read_b64_tr_b16 v[120:121], v7 offset:8192
    ds_read_b64_tr_b16 v[122:123], v7 offset:9216
    v_cvt_pk_bf16_f32 v201, v66, v67
    ds_write_b32 v8, v201 offset:640
    s_waitcnt lgkmcnt(15)
    v_mfma_f32_32x32x16_bf16 v[80:95], v[36:39], v[132:135], v[80:95]
    ds_read_b64_tr_b16 v[124:125], v7 offset:12288
    ds_read_b64_tr_b16 v[126:127], v7 offset:13312
    v_cvt_pk_bf16_f32 v202, v68, v69
    ds_write_b32 v8, v202 offset:2176
    s_waitcnt lgkmcnt(15)
    v_mfma_f32_32x32x16_bf16 v[80:95], v[40:43], v[136:139], v[80:95]
    ds_read_b64_tr_b16 v[128:129], v7 offset:16384
    ds_read_b64_tr_b16 v[130:131], v7 offset:17408
    v_cvt_pk_bf16_f32 v203, v70, v71
    ds_write_b32 v8, v203 offset:2688
    s_waitcnt lgkmcnt(15)
    v_mfma_f32_32x32x16_bf16 v[80:95], v[44:47], v[140:143], v[80:95]
    ds_read_b64_tr_b16 v[132:133], v7 offset:20480
    ds_read_b64_tr_b16 v[134:135], v7 offset:21504
    v_cvt_pk_bf16_f32 v204, v72, v73
    ds_write_b32 v8, v204 offset:4224
    s_waitcnt lgkmcnt(15)
    v_mfma_f32_32x32x16_bf16 v[96:111], v[16:19], v[112:115], 0
    ds_read_b64_tr_b16 v[136:137], v7 offset:24576
    ds_read_b64_tr_b16 v[138:139], v7 offset:25600
    v_cvt_pk_bf16_f32 v205, v74, v75
    ds_write_b32 v8, v205 offset:4736
    s_waitcnt lgkmcnt(15)
    v_mfma_f32_32x32x16_bf16 v[96:111], v[20:23], v[116:119], v[96:111]
    ds_read_b64_tr_b16 v[140:141], v7 offset:28672
    ds_read_b64_tr_b16 v[142:143], v7 offset:29696
    v_cvt_pk_bf16_f32 v206, v76, v77
    ds_write_b32 v8, v206 offset:6272
    s_waitcnt lgkmcnt(15)
    v_mfma_f32_32x32x16_bf16 v[96:111], v[24:27], v[120:123], v[96:111]
    v_cvt_pk_bf16_f32 v207, v78, v79
    ds_write_b32 v8, v207 offset:6784
    s_waitcnt lgkmcnt(14)
    v_mfma_f32_32x32x16_bf16 v[96:111], v[28:31], v[124:127], v[96:111]
    v_cvt_pk_bf16_f32 v200, v80, v81
    ds_write_b32 v8, v200 offset:256
    s_waitcnt lgkmcnt(12)
    v_mfma_f32_32x32x16_bf16 v[96:111], v[32:35], v[128:131], v[96:111]
    v_cvt_pk_bf16_f32 v201, v82, v83
    ds_write_b32 v8, v201 offset:768
    s_waitcnt lgkmcnt(10)
    v_mfma_f32_32x32x16_bf16 v[96:111], v[36:39], v[132:135], v[96:111]
    v_cvt_pk_bf16_f32 v202, v84, v85
    ds_write_b32 v8, v202 offset:2304
    s_waitcnt lgkmcnt(8)
    v_mfma_f32_32x32x16_bf16 v[96:111], v[40:43], v[136:139], v[96:111]
    v_cvt_pk_bf16_f32 v203, v86, v87
    ds_write_b32 v8, v203 offset:2816
    s_waitcnt lgkmcnt(6)
    v_mfma_f32_32x32x16_bf16 v[96:111], v[44:47], v[140:143], v[96:111]
    v_cvt_pk_bf16_f32 v204, v88, v89
    ds_write_b32 v8, v204 offset:4352
    s_nop 3
    v_cvt_pk_bf16_f32 v205, v90, v91
    ds_write_b32 v8, v205 offset:4864
    v_cvt_pk_bf16_f32 v206, v92, v93
    ds_write_b32 v8, v206 offset:6400
    v_cvt_pk_bf16_f32 v207, v94, v95
    ds_write_b32 v8, v207 offset:6912
    v_cvt_pk_bf16_f32 v200, v96, v97
    ds_write_b32 v8, v200 offset:384
    v_cvt_pk_bf16_f32 v201, v98, v99
    ds_write_b32 v8, v201 offset:896
    v_cvt_pk_bf16_f32 v202, v100, v101
    ds_write_b32 v8, v202 offset:2432
    v_cvt_pk_bf16_f32 v203, v102, v103
    ds_write_b32 v8, v203 offset:2944
    v_cvt_pk_bf16_f32 v204, v104, v105
    ds_write_b32 v8, v204 offset:4480
    v_cvt_pk_bf16_f32 v205, v106, v107
    ds_write_b32 v8, v205 offset:4992
    v_cvt_pk_bf16_f32 v206, v108, v109
    ds_write_b32 v8, v206 offset:6528
    v_cvt_pk_bf16_f32 v207, v110, v111
    ds_write_b32 v8, v207 offset:7040
    s_waitcnt lgkmcnt(0)
    v_lshl_add_u32 v2, v1, 4, s69
    ds_read_b128 v[16:19], v2 offset:0
    ds_read_b128 v[20:23], v2 offset:1024
    ds_read_b128 v[24:27], v2 offset:2048
    ds_read_b128 v[28:31], v2 offset:3072
    ds_read_b128 v[32:35], v2 offset:4096
    ds_read_b128 v[36:39], v2 offset:5120
    ds_read_b128 v[40:43], v2 offset:6144
    ds_read_b128 v[44:47], v2 offset:7168
    v_lshrrev_b32 v3, 5, v1
    v_mul_u32_u24 v3, 40960, v3
    v_bfe_u32 v4, v1, 3, 2
    v_lshl_add_u32 v3, v4, 11, v3
    v_and_b32 v4, 7, v1
    v_lshl_add_u32 v3, v4, 4, v3
    s_mul_i32 s69, s47, 655360
    s_lshl_b32 s68, s68, 13
    s_add_u32 s69, s69, s68
    s_lshl_b32 s67, s67, 7
    s_add_u32 s69, s69, s67
    s_add_u32 s69, s69, 3145728
    s_waitcnt lgkmcnt(7)
    buffer_store_dwordx4 v[16:19], v3, s[36:39], s69 offen sc1
    s_add_u32 s69, s69, 81920
    s_waitcnt lgkmcnt(6)
    buffer_store_dwordx4 v[20:23], v3, s[36:39], s69 offen sc1
    s_add_u32 s69, s69, 81920
    s_waitcnt lgkmcnt(5)
    buffer_store_dwordx4 v[24:27], v3, s[36:39], s69 offen sc1
    s_add_u32 s69, s69, 81920
    s_waitcnt lgkmcnt(4)
    buffer_store_dwordx4 v[28:31], v3, s[36:39], s69 offen sc1
    s_add_u32 s69, s69, 81920
    s_waitcnt lgkmcnt(3)
    buffer_store_dwordx4 v[32:35], v3, s[36:39], s69 offen sc1
    s_add_u32 s69, s69, 81920
    s_waitcnt lgkmcnt(2)
    buffer_store_dwordx4 v[36:39], v3, s[36:39], s69 offen sc1
    s_add_u32 s69, s69, 81920
    s_waitcnt lgkmcnt(1)
    buffer_store_dwordx4 v[40:43], v3, s[36:39], s69 offen sc1
    s_add_u32 s69, s69, 81920
    s_waitcnt lgkmcnt(0)
    buffer_store_dwordx4 v[44:47], v3, s[36:39], s69 offen sc1
L_QSET:
    s_mul_i32 s66, s47, 1600
    s_lshr_b32 s67, s47, 1
    s_mul_i32 s67, s67, 1280
    s_add_u32 s66, s66, s67
    s_add_u32 s66, s66, 156160
    v_lshl_add_u32 v2, v1, 4, s66
    s_and_b32 s67, s47, 1
    s_cmp_eq_u32 s67, 0
    s_cselect_b32 s67, -1, 0
    s_not_b32 s68, s67
    s_waitcnt vmcnt(8)
    v_and_b32 v226, s68, v224
    v_and_b32 v227, s68, v225
    v_and_b32 v224, s67, v224
    v_and_b32 v225, s67, v225
    v_and_b32 v230, s68, v228
    v_and_b32 v231, s68, v229
    v_and_b32 v228, s67, v228
    v_and_b32 v229, s67, v229
    ds_write_b128 v2, v[224:227]
    v_cmp_gt_u32 vcc, 36, v1
    s_and_saveexec_b64 s[64:65], vcc
    ds_write_b128 v2, v[228:231] offset:1024
    s_mov_b64 exec, 0xfffff
    s_mul_i32 s66, s47, 320
    s_add_u32 s66, s66, 159360
    v_lshl_add_u32 v2, v1, 4, s66
    v_mov_b32 v232, 0
    v_mov_b32 v233, 0
    v_mov_b32 v234, 0
    v_mov_b32 v235, 0
    ds_write_b128 v2, v[232:235]
    s_mov_b64 exec, s[64:65]
    s_mul_i32 s66, s47, 3072
    s_add_u32 s66, s66, 139392
    v_lshl_add_u32 v188, v1, 4, s66
    v_bfe_u32 v10, v1, 4, 1
    v_bfe_u32 v11, v1, 2, 2
    v_and_b32 v12, 3, v1
    v_lshrrev_b32 v9, 5, v1
    v_lshl_add_u32 v13, v10, 2, v12
    v_lshl_add_u32 v14, v9, 3, v11
    v_mul_u32_u24 v14, 80, v14
    v_lshl_add_u32 v14, v13, 3, v14
    s_mul_i32 s66, s62, 3840
    s_add_u32 s66, s66, 156160
    v_add_u32 v189, s66, v14
    v_mov_b32 v193, 0x40000000
    v_mov_b32 v194, 0x40000000
    v_add_u32 v4, 0, v1
    v_add_u32 v5, 64, v1
    v_add_u32 v6, 128, v1
    v_add_u32 v7, 192, v1
    v_add_u32 v8, 256, v1
    v_mul_u32_u24 v245, 6554, v4
    v_mul_u32_u24 v246, 6554, v5
    v_mul_u32_u24 v247, 6554, v6
    v_mul_u32_u24 v248, 6554, v7
    v_mul_u32_u24 v249, 6554, v8
    v_lshrrev_b32 v245, 16, v245
    v_lshrrev_b32 v246, 16, v246
    v_lshrrev_b32 v247, 16, v247
    v_lshrrev_b32 v248, 16, v248
    v_lshrrev_b32 v249, 16, v249
    v_mul_u32_u24 v245, 1120, v245
    v_mul_u32_u24 v246, 1120, v246
    v_mul_u32_u24 v247, 1120, v247
    v_mul_u32_u24 v248, 1120, v248
    v_mul_u32_u24 v249, 1120, v249
    v_lshl_add_u32 v245, v4, 4, v245
    v_lshl_add_u32 v246, v5, 4, v246
    v_lshl_add_u32 v247, v6, 4, v247
    v_lshl_add_u32 v248, v7, 4, v248
    v_lshl_add_u32 v249, v8, 4, v249
    v_subrev_u32 v246, 1024, v246
    v_subrev_u32 v247, 2048, v247
    v_subrev_u32 v248, 3072, v248
    v_and_b32 v2, 15, v1
    v_bfe_u32 v3, v1, 1, 3
    v_lshrrev_b32 v9, 4, v1
    v_xor_b32 v3, v3, v9
    s_lshl_b32 s66, s47, 12
    v_lshlrev_b32 v2, 7, v2
    v_lshl_add_u32 v2, v3, 4, v2
    v_add_u32 v144, s66, v2
    v_xor_b32 v145, 64, v144
    v_add_u32 v146, 28672, v144
    v_add_u32 v147, 28672, v145
    v_add_u32 v148, 57344, v144
    v_add_u32 v149, 57344, v145
    v_bfe_u32 v11, v1, 2, 2
    v_and_b32 v12, 3, v1
    v_lshl_add_u32 v11, v9, 3, v11
    v_mul_u32_u24 v11, 192, v11
    v_lshl_add_u32 v11, v12, 3, v11
    v_and_b32 v10, 1, v9
    v_lshlrev_b32 v10, 5, v10
    v_add_u32 v12, v11, v10
    v_sub_u32 v11, v11, v10
    v_add_u32 v150, 16384, v12
    v_add_u32 v151, 16384, v11
    v_add_u32 v152, 45056, v12
    v_add_u32 v153, 45056, v11
    v_add_u32 v154, 73728, v12
    v_add_u32 v155, 73728, v11
    v_lshrrev_b32 v2, 5, v1
    v_bfe_u32 v3, v1, 4, 1
    v_and_b32 v9, 15, v1
    v_lshlrev_b32 v4, 10, v2
    v_lshl_add_u32 v4, v3, 9, v4
    v_lshl_add_u32 v209, v9, 4, v4
    v_mul_u32_u24 v5, 5120, v2
    v_lshl_add_u32 v5, v3, 8, v5
    v_lshl_add_u32 v210, v9, 3, v5
    v_bfe_u32 v10, v1, 2, 2
    v_and_b32 v11, 3, v1
    v_mul_u32_u24 v12, 20, v3
    v_add_u32 v12, v12, v10
    v_lshl_add_u32 v6, v2, 3, v12
    v_mul_u32_u24 v6, 160, v6
    v_lshl_add_u32 v6, v11, 3, v6
    v_mul_u32_u24 v7, 80, v2
    v_add3_u32 v7, v7, v12, 16
    v_mul_u32_u24 v7, 160, v7
    v_lshl_add_u32 v7, v11, 3, v7
    s_mul_i32 s66, s62, 51200
    s_add_u32 s66, s66, 36864
    v_add_u32 v211, s66, v6
    v_add_u32 v212, s66, v7
    s_and_b32 s66, s45, 3
    s_lshl2_add_u32 s66, s44, s66
    s_lshr_b32 s3, s66, 1
    s_bfe_u32 s68, s45, 0x20002
    s_lshl2_add_u32 s3, s3, s68
    s_lshl_b32 s3, s3, 8
    s_add_u32 s3, s3, 147456
    s_lshr_b32 s68, s47, 1
    s_lshl1_add_u32 s67, s66, s68
    s_lshl1_add_u32 s67, s67, s62
    s_mul_i32 s67, s67, 20480
    s_add_u32 s67, s67, 524288
    s_and_b32 s68, s47, 1
    s_lshl_b32 s69, s68, 7
    s_add_u32 s69, s69, s67
    s_add_u32 s4, s69, 4096
    s_lshl_b32 s68, s68, 8
    s_add_u32 s5, s67, s68
    s_lshl2_add_u32 s66, s66, s47
    s_mul_i32 s66, s66, 40960
    s_lshr_b32 s68, s45, 2
    s_mul_i32 s68, s68, 160
    s_add_u32 s6, s66, s68
    v_mul_u32_u24 v8, 2560, v9
    v_lshrrev_b32 v2, 4, v1
    v_lshl_add_u32 v213, v2, 3, v8
    v_lshrrev_b32 v2, 5, v1
    v_lshl_add_u32 v8, v3, 5, v8
    v_lshl_add_u32 v215, v2, 4, v8
    s_mul_i32 s66, s47, 5120
    s_add_u32 s66, s66, 0
    v_lshl_add_u32 v214, v1, 4, s66
    v_mul_u32_u24 v3, 6554, v0
    v_lshrrev_b32 v3, 16, v3
    v_lshlrev_b32 v6, 5, v3
    v_lshl_add_u32 v6, v0, 4, v6
    v_cmp_gt_u32 vcc, 440, v0
    v_mov_b32 v15, 0x40000000
    v_mul_u32_u24 v8, 80, v3
    v_cndmask_b32 v6, v15, v6, vcc
    v_lshl_add_u32 v8, v0, 3, v8
    v_add_u32 v8, 155136, v8
    v_mov_b32 v7, 0xffff0000
    v_bfe_u32 v9, v1, 2, 1
    v_bfe_u32 v10, v1, 3, 2
    v_and_b32 v11, 3, v1
    v_lshl_add_u32 v10, v10, 2, v11
    v_add_u32 v11, 16, v10
    v_min_u32 v11, 20, v11
    v_mul_u32_u24 v12, 22, v9
    s_mul_i32 s66, s62, 44
    v_add_u32 v12, s66, v12
    v_add_u32 v10, v10, v12
    v_add_u32 v11, v11, v12
    v_mul_u32_u24 v10, 80, v10
    v_mul_u32_u24 v11, 80, v11
    v_lshrrev_b32 v12, 5, v1
    v_cmp_eq_u32 vcc, v12, v9
    v_mov_b32 v13, 7040
    s_mul_i32 s67, s42, 8448
    v_cndmask_b32 v10, v13, v10, vcc
    v_cndmask_b32 v11, v13, v11, vcc
    v_add_u32 v10, 155136, v10
    v_add_u32 v11, 155136, v11
    s_lshl_b32 s68, s41, 2
    s_add_u32 s68, s68, s47
    s_lshl_b32 s68, s68, 3
    s_add_u32 s68, s68, s42
    s_mul_i32 s68, s68, 5120
    s_add_u32 s68, s68, 524288
    s_lshl_b32 s69, s62, 9
    s_add_u32 s69, s69, s68
    s_add_u32 s69, s69, 4096
    s_lshl_b32 s70, s62, 11
    s_add_u32 s68, s68, s70
    v_lshlrev_b32 v12, 4, v1
    v_lshlrev_b32 v13, 3, v1
    v_mov_b32 v199, v6
    v_mov_b32 v200, v7
    v_mov_b32 v201, v8
    v_mov_b32 v202, v10
    v_mov_b32 v203, v11
    v_mov_b32 v204, v12
    v_mov_b32 v205, v13
    s_mov_b32 s7, s67
    s_mov_b32 s46, s68
    s_mov_b32 s54, s69
    s_cmp_ge_u32 s2, 208
    s_cbranch_scc0 L_NOZPF
    s_lshl2_add_u32 s66, s43, s47
    s_add_u32 s66, s66, -24
    s_max_i32 s68, s66, -8
    s_add_u32 s68, s68, 10
    s_mul_i32 s67, s68, 205
    s_lshr_b32 s67, s67, 11
    s_lshl3_add_u32 s66, s67, s66
    s_add_u32 s66, s66, 90
    s_min_u32 s66, s66, 188
    s_mul_i32 s67, s66, 3641
    s_lshr_b32 s67, s67, 16
    s_mul_i32 s68, s67, 18
    s_sub_u32 s68, s66, s68
    s_cmp_ge_u32 s68, 8
    s_cbranch_scc1 PFW_38
    s_and_b32 s69, s44, 3
    s_lshl_b32 s69, s69, 3
    s_add_u32 s69, s69, s68
    s_mul_i32 s69, s69, 81920
    s_lshl_b32 s67, s67, 7
    s_add_u32 s69, s69, s67
    v_mul_u32_u24 v250, 1280, v1
    buffer_load_dword v251, v250, s[8:11], s69 offen
    s_branch NOPF_37
PFW_38:
    s_sub_u32 s68, s68, 8
    s_cmp_ge_u32 s68, 5
    s_cselect_b32 s69, 640, 0
    s_lshl_b32 s68, s68, 7
    s_add_u32 s69, s69, s68
    s_lshr_b32 s68, s44, 2
    s_mul_i32 s68, s68, 640
    s_add_u32 s69, s69, s68
    s_mul_i32 s67, s67, 245760
    s_add_u32 s69, s69, s67
    s_add_u32 s69, s69, 1280
    v_mul_u32_u24 v250, 3840, v1
    buffer_load_dword v251, v250, s[12:15], s69 offen
NOPF_37:
    s_lshl2_add_u32 s66, s43, s47
    s_add_u32 s66, s66, 0
    s_max_i32 s68, s66, -8
    s_add_u32 s68, s68, 10
    s_mul_i32 s67, s68, 205
    s_lshr_b32 s67, s67, 11
    s_lshl3_add_u32 s66, s67, s66
    s_add_u32 s66, s66, 90
    s_min_u32 s66, s66, 188
    s_mul_i32 s67, s66, 3641
    s_lshr_b32 s67, s67, 16
    s_mul_i32 s68, s67, 18
    s_sub_u32 s68, s66, s68
    s_cmp_ge_u32 s68, 8
    s_cbranch_scc1 PFW_40
    s_and_b32 s69, s44, 3
    s_lshl_b32 s69, s69, 3
    s_add_u32 s69, s69, s68
    s_mul_i32 s69, s69, 81920
    s_lshl_b32 s67, s67, 7
    s_add_u32 s69, s69, s67
    v_mul_u32_u24 v250, 1280, v1
    buffer_load_dword v251, v250, s[8:11], s69 offen
    s_branch NOPF_39
PFW_40:
    s_sub_u32 s68, s68, 8
    s_cmp_ge_u32 s68, 5
    s_cselect_b32 s69, 640, 0
    s_lshl_b32 s68, s68, 7
    s_add_u32 s69, s69, s68
    s_lshr_b32 s68, s44, 2
    s_mul_i32 s68, s68, 640
    s_add_u32 s69, s69, s68
    s_mul_i32 s67, s67, 245760
    s_add_u32 s69, s69, s67
    s_add_u32 s69, s69, 1280
    v_mul_u32_u24 v250, 3840, v1
    buffer_load_dword v251, v250, s[12:15], s69 offen
NOPF_39:
L_NOZPF:
    s_waitcnt lgkmcnt(0)
    s_barrier
    ds_read_b128 v[56:59], v144 offset:0
    ds_read_b128 v[60:63], v144 offset:2048
    ds_read_b64_tr_b16 v[112:113], v150 offset:0
    ds_read_b64_tr_b16 v[114:115], v150 offset:768
    ds_read_b64_tr_b16 v[116:117], v151 offset:32
    ds_read_b64_tr_b16 v[118:119], v151 offset:800
    ds_read_b64_tr_b16 v[120:121], v150 offset:64
    ds_read_b64_tr_b16 v[122:123], v150 offset:832
    ds_read_b64_tr_b16 v[124:125], v151 offset:96
    ds_read_b64_tr_b16 v[126:127], v151 offset:864
    ds_read_b64_tr_b16 v[128:129], v150 offset:128
    ds_read_b64_tr_b16 v[130:131], v150 offset:896
    s_waitcnt lgkmcnt(6)
    v_mfma_f32_16x16x32_bf16 v[16:19], v[112:115], v[56:59], 0
    ds_read_b128 v[64:67], v145 offset:0
    ds_read_b128 v[68:71], v145 offset:2048
    v_mfma_f32_16x16x32_bf16 v[20:23], v[112:115], v[60:63], 0
    ds_read_b64_tr_b16 v[132:133], v150 offset:6144
    ds_read_b64_tr_b16 v[134:135], v150 offset:6912
    v_mfma_f32_16x16x32_bf16 v[24:27], v[116:119], v[56:59], 0
    ds_read_b64_tr_b16 v[136:137], v151 offset:6176
    ds_read_b64_tr_b16 v[138:139], v151 offset:6944
    v_mfma_f32_16x16x32_bf16 v[28:31], v[116:119], v[60:63], 0
    ds_read_b64_tr_b16 v[140:141], v150 offset:6208
    ds_read_b64_tr_b16 v[142:143], v150 offset:6976
    s_waitcnt lgkmcnt(10)
    v_mfma_f32_16x16x32_bf16 v[32:35], v[120:123], v[56:59], 0
    ds_read_b64_tr_b16 v[112:113], v151 offset:6240
    v_mfma_f32_16x16x32_bf16 v[36:39], v[120:123], v[60:63], 0
    ds_read_b64_tr_b16 v[114:115], v151 offset:7008
    v_mfma_f32_16x16x32_bf16 v[40:43], v[124:127], v[56:59], 0
    ds_read_b64_tr_b16 v[116:117], v150 offset:6272
    v_mfma_f32_16x16x32_bf16 v[44:47], v[124:127], v[60:63], 0
    ds_read_b64_tr_b16 v[118:119], v150 offset:7040
    s_waitcnt lgkmcnt(8)
    v_mfma_f32_16x16x32_bf16 v[48:51], v[128:131], v[56:59], 0
    v_mfma_f32_16x16x32_bf16 v[52:55], v[128:131], v[60:63], 0
    v_mfma_f32_16x16x32_bf16 v[16:19], v[132:135], v[64:67], v[16:19]
    v_mfma_f32_16x16x32_bf16 v[20:23], v[132:135], v[68:71], v[20:23]
    s_waitcnt lgkmcnt(4)
    v_mfma_f32_16x16x32_bf16 v[24:27], v[136:139], v[64:67], v[24:27]
    v_mfma_f32_16x16x32_bf16 v[28:31], v[136:139], v[68:71], v[28:31]
    s_waitcnt lgkmcnt(0)
    s_barrier
    s_cmp_eq_u32 s40, 0
    s_cbranch_scc0 NOLOOK_41
    v_mov_b32 v2, 0
    buffer_load_dword v14, v2, s[32:35], 0 offen sc1
NOLOOK_41:
    v_mfma_f32_16x16x32_bf16 v[32:35], v[140:143], v[64:67], v[32:35]
    ds_read_b128 v[72:75], v146 offset:0
    ds_read_b128 v[76:79], v146 offset:2048
    v_mfma_f32_16x16x32_bf16 v[36:39], v[140:143], v[68:71], v[36:39]
    ds_read_b64_tr_b16 v[120:121], v152 offset:0
    ds_read_b64_tr_b16 v[122:123], v152 offset:768
    v_mfma_f32_16x16x32_bf16 v[40:43], v[112:115], v[64:67], v[40:43]
    ds_read_b64_tr_b16 v[124:125], v153 offset:32
    ds_read_b64_tr_b16 v[126:127], v153 offset:800
    v_mfma_f32_16x16x32_bf16 v[44:47], v[112:115], v[68:71], v[44:47]
    ds_read_b64_tr_b16 v[128:129], v152 offset:64
    ds_read_b64_tr_b16 v[130:131], v152 offset:832
    v_mfma_f32_16x16x32_bf16 v[48:51], v[116:119], v[64:67], v[48:51]
    ds_read_b64_tr_b16 v[132:133], v153 offset:96
    ds_read_b64_tr_b16 v[134:135], v153 offset:864
    v_mfma_f32_16x16x32_bf16 v[52:55], v[116:119], v[68:71], v[52:55]
    ds_read_b64_tr_b16 v[136:137], v152 offset:128
    ds_read_b64_tr_b16 v[138:139], v152 offset:896
    s_waitcnt lgkmcnt(6)
    v_mfma_f32_16x16x32_bf16 v[16:19], v[120:123], v[72:75], v[16:19]
    ds_read_b128 v[80:83], v147 offset:0
    ds_read_b128 v[84:87], v147 offset:2048
    v_mfma_f32_16x16x32_bf16 v[20:23], v[120:123], v[76:79], v[20:23]
    ds_read_b64_tr_b16 v[140:141], v152 offset:6144
    ds_read_b64_tr_b16 v[142:143], v152 offset:6912
    v_mfma_f32_16x16x32_bf16 v[24:27], v[124:127], v[72:75], v[24:27]
    ds_read_b64_tr_b16 v[112:113], v153 offset:6176
    ds_read_b64_tr_b16 v[114:115], v153 offset:6944
    v_mfma_f32_16x16x32_bf16 v[28:31], v[124:127], v[76:79], v[28:31]
    ds_read_b64_tr_b16 v[116:117], v152 offset:6208
    ds_read_b64_tr_b16 v[118:119], v152 offset:6976
    s_waitcnt lgkmcnt(10)
    v_mfma_f32_16x16x32_bf16 v[32:35], v[128:131], v[72:75], v[32:35]
    ds_read_b64_tr_b16 v[120:121], v153 offset:6240
    v_mfma_f32_16x16x32_bf16 v[36:39], v[128:131], v[76:79], v[36:39]
    ds_read_b64_tr_b16 v[122:123], v153 offset:7008
    v_mfma_f32_16x16x32_bf16 v[40:43], v[132:135], v[72:75], v[40:43]
    ds_read_b64_tr_b16 v[124:125], v152 offset:6272
    v_mfma_f32_16x16x32_bf16 v[44:47], v[132:135], v[76:79], v[44:47]
    ds_read_b64_tr_b16 v[126:127], v152 offset:7040
    s_waitcnt lgkmcnt(8)
    v_mfma_f32_16x16x32_bf16 v[48:51], v[136:139], v[72:75], v[48:51]
    v_mfma_f32_16x16x32_bf16 v[52:55], v[136:139], v[76:79], v[52:55]
    v_mfma_f32_16x16x32_bf16 v[16:19], v[140:143], v[80:83], v[16:19]
    v_mfma_f32_16x16x32_bf16 v[20:23], v[140:143], v[84:87], v[20:23]
    s_waitcnt lgkmcnt(4)
    v_mfma_f32_16x16x32_bf16 v[24:27], v[112:115], v[80:83], v[24:27]
    v_mfma_f32_16x16x32_bf16 v[28:31], v[112:115], v[84:87], v[28:31]
    s_waitcnt lgkmcnt(0)
    s_barrier
    v_mfma_f32_16x16x32_bf16 v[32:35], v[116:119], v[80:83], v[32:35]
    ds_read_b128 v[56:59], v148 offset:0
    ds_read_b128 v[60:63], v148 offset:2048
    v_mfma_f32_16x16x32_bf16 v[36:39], v[116:119], v[84:87], v[36:39]
    ds_read_b64_tr_b16 v[128:129], v154 offset:0
    ds_read_b64_tr_b16 v[130:131], v154 offset:768
    v_mfma_f32_16x16x32_bf16 v[40:43], v[120:123], v[80:83], v[40:43]
    ds_read_b64_tr_b16 v[132:133], v155 offset:32
    ds_read_b64_tr_b16 v[134:135], v155 offset:800
    v_mfma_f32_16x16x32_bf16 v[44:47], v[120:123], v[84:87], v[44:47]
    ds_read_b64_tr_b16 v[136:137], v154 offset:64
    ds_read_b64_tr_b16 v[138:139], v154 offset:832
    v_mfma_f32_16x16x32_bf16 v[48:51], v[124:127], v[80:83], v[48:51]
    ds_read_b64_tr_b16 v[140:141], v155 offset:96
    ds_read_b64_tr_b16 v[142:143], v155 offset:864
    v_mfma_f32_16x16x32_bf16 v[52:55], v[124:127], v[84:87], v[52:55]
    ds_read_b64_tr_b16 v[112:113], v154 offset:128
    ds_read_b64_tr_b16 v[114:115], v154 offset:896
    s_waitcnt lgkmcnt(6)
    v_mfma_f32_16x16x32_bf16 v[16:19], v[128:131], v[56:59], v[16:19]
    ds_read_b128 v[64:67], v149 offset:0
    ds_read_b128 v[68:71], v149 offset:2048
    v_mfma_f32_16x16x32_bf16 v[20:23], v[128:131], v[60:63], v[20:23]
    ds_read_b64_tr_b16 v[116:117], v154 offset:6144
    ds_read_b64_tr_b16 v[118:119], v154 offset:6912
    v_mfma_f32_16x16x32_bf16 v[24:27], v[132:135], v[56:59], v[24:27]
    ds_read_b64_tr_b16 v[120:121], v155 offset:6176
    ds_read_b64_tr_b16 v[122:123], v155 offset:6944
    v_mfma_f32_16x16x32_bf16 v[28:31], v[132:135], v[60:63], v[28:31]
    ds_read_b64_tr_b16 v[124:125], v154 offset:6208
    ds_read_b64_tr_b16 v[126:127], v154 offset:6976
    s_waitcnt lgkmcnt(10)
    v_mfma_f32_16x16x32_bf16 v[32:35], v[136:139], v[56:59], v[32:35]
    ds_read_b64_tr_b16 v[128:129], v155 offset:6240
    v_mfma_f32_16x16x32_bf16 v[36:39], v[136:139], v[60:63], v[36:39]
    ds_read_b64_tr_b16 v[130:131], v155 offset:7008
    v_mfma_f32_16x16x32_bf16 v[40:43], v[140:143], v[56:59], v[40:43]
    ds_read_b64_tr_b16 v[132:133], v154 offset:6272
    v_mfma_f32_16x16x32_bf16 v[44:47], v[140:143], v[60:63], v[44:47]
    ds_read_b64_tr_b16 v[134:135], v154 offset:7040
    s_waitcnt lgkmcnt(8)
    v_mfma_f32_16x16x32_bf16 v[48:51], v[112:115], v[56:59], v[48:51]
    v_mfma_f32_16x16x32_bf16 v[52:55], v[112:115], v[60:63], v[52:55]
    v_mfma_f32_16x16x32_bf16 v[16:19], v[116:119], v[64:67], v[16:19]
    v_mfma_f32_16x16x32_bf16 v[20:23], v[116:119], v[68:71], v[20:23]
    s_waitcnt lgkmcnt(4)
    v_mfma_f32_16x16x32_bf16 v[24:27], v[120:123], v[64:67], v[24:27]
    v_mfma_f32_16x16x32_bf16 v[28:31], v[120:123], v[68:71], v[28:31]
    s_waitcnt vmcnt(0) lgkmcnt(0)
    s_barrier
    s_cmp_eq_u32 s40, 0
    s_cbranch_scc0 INITE_43
    v_readfirstlane_b32 s61, v14
    s_nop 0
    s_cmp_ge_u32 s61, 48
    s_cbranch_scc1 INITOK_42
    v_mov_b32 v2, 0
    s_mov_b32 s63, 131072
    s_mov_b64 exec, 1
POLL_44:
    v_mov_b32 v3, 0
    buffer_atomic_add v3, v2, s[32:35], 0 offen sc0
    s_waitcnt vmcnt(0)
    v_readfirstlane_b32 s61, v3
    s_sub_u32 s63, s63, 1
    s_cbranch_scc1 POLLD_45
    s_cmp_ge_u32 s61, 48
    s_cbranch_scc1 POLLD_45
    s_sleep 32
    s_branch POLL_44
POLLD_45:
    s_mov_b64 exec, -1
INITOK_42:
    s_cmp_ge_u32 s2, 208
    s_cbranch_scc1 INITE_43
    v_lshlrev_b32 v2, 8, v1
    v_mov_b32 v3, 1
    s_mov_b32 s60, 163840
    s_mov_b64 exec, 0xff
    buffer_atomic_add v3, v2, s[36:39], s60 offen
    s_mov_b64 exec, -1
INITE_43:
    v_mfma_f32_16x16x32_bf16 v[32:35], v[124:127], v[64:67], v[32:35]
    ds_read_b128 v[72:75], v144 offset:0
    ds_read_b128 v[76:79], v144 offset:2048
    v_mfma_f32_16x16x32_bf16 v[36:39], v[124:127], v[68:71], v[36:39]
    ds_read_b64_tr_b16 v[136:137], v150 offset:0
    ds_read_b64_tr_b16 v[138:139], v150 offset:768
    v_mfma_f32_16x16x32_bf16 v[40:43], v[128:131], v[64:67], v[40:43]
    ds_read_b64_tr_b16 v[140:141], v151 offset:32
    ds_read_b64_tr_b16 v[142:143], v151 offset:800
    v_mfma_f32_16x16x32_bf16 v[44:47], v[128:131], v[68:71], v[44:47]
    ds_read_b64_tr_b16 v[112:113], v150 offset:64
    ds_read_b64_tr_b16 v[114:115], v150 offset:832
    v_mfma_f32_16x16x32_bf16 v[48:51], v[132:135], v[64:67], v[48:51]
    ds_read_b64_tr_b16 v[116:117], v151 offset:96
    ds_read_b64_tr_b16 v[118:119], v151 offset:864
    v_mfma_f32_16x16x32_bf16 v[52:55], v[132:135], v[68:71], v[52:55]
    ds_read_b64_tr_b16 v[120:121], v150 offset:128
    ds_read_b64_tr_b16 v[122:123], v150 offset:896
    s_waitcnt lgkmcnt(6)
    v_mfma_f32_16x16x32_bf16 v[16:19], v[136:139], v[72:75], v[16:19]
    ds_read_b128 v[80:83], v145 offset:0
    ds_read_b128 v[84:87], v145 offset:2048
    v_mfma_f32_16x16x32_bf16 v[20:23], v[136:139], v[76:79], v[20:23]
    ds_read_b64_tr_b16 v[124:125], v150 offset:6144
    ds_read_b64_tr_b16 v[126:127], v150 offset:6912
    v_mfma_f32_16x16x32_bf16 v[24:27], v[140:143], v[72:75], v[24:27]
    ds_read_b64_tr_b16 v[128:129], v151 offset:6176
    ds_read_b64_tr_b16 v[130:131], v151 offset:6944
    v_mfma_f32_16x16x32_bf16 v[28:31], v[140:143], v[76:79], v[28:31]
    ds_read_b64_tr_b16 v[132:133], v150 offset:6208
    ds_read_b64_tr_b16 v[134:135], v150 offset:6976
    s_waitcnt lgkmcnt(10)
    v_mfma_f32_16x16x32_bf16 v[32:35], v[112:115], v[72:75], v[32:35]
    ds_read_b64_tr_b16 v[136:137], v151 offset:6240
    v_mfma_f32_16x16x32_bf16 v[36:39], v[112:115], v[76:79], v[36:39]
    ds_read_b64_tr_b16 v[138:139], v151 offset:7008
    v_mfma_f32_16x16x32_bf16 v[40:43], v[116:119], v[72:75], v[40:43]
    ds_read_b64_tr_b16 v[140:141], v150 offset:6272
    v_mfma_f32_16x16x32_bf16 v[44:47], v[116:119], v[76:79], v[44:47]
    ds_read_b64_tr_b16 v[142:143], v150 offset:7040
    s_waitcnt lgkmcnt(8)
    v_mfma_f32_16x16x32_bf16 v[48:51], v[120:123], v[72:75], v[48:51]
    v_mfma_f32_16x16x32_bf16 v[52:55], v[120:123], v[76:79], v[52:55]
    v_mfma_f32_16x16x32_bf16 v[16:19], v[124:127], v[80:83], v[16:19]
    v_mfma_f32_16x16x32_bf16 v[20:23], v[124:127], v[84:87], v[20:23]
    s_waitcnt lgkmcnt(4)
    v_mfma_f32_16x16x32_bf16 v[24:27], v[128:131], v[80:83], v[24:27]
    v_mfma_f32_16x16x32_bf16 v[28:31], v[128:131], v[84:87], v[28:31]
    s_waitcnt lgkmcnt(0)
    s_barrier
    v_mfma_f32_16x16x32_bf16 v[32:35], v[132:135], v[80:83], v[32:35]
    ds_read_b128 v[56:59], v146 offset:0
    ds_read_b128 v[60:63], v146 offset:2048
    v_mfma_f32_16x16x32_bf16 v[36:39], v[132:135], v[84:87], v[36:39]
    ds_read_b64_tr_b16 v[112:113], v152 offset:0
    ds_read_b64_tr_b16 v[114:115], v152 offset:768
    v_mfma_f32_16x16x32_bf16 v[40:43], v[136:139], v[80:83], v[40:43]
    ds_read_b64_tr_b16 v[116:117], v153 offset:32
    ds_read_b64_tr_b16 v[118:119], v153 offset:800
    v_mfma_f32_16x16x32_bf16 v[44:47], v[136:139], v[84:87], v[44:47]
    ds_read_b64_tr_b16 v[120:121], v152 offset:64
    ds_read_b64_tr_b16 v[122:123], v152 offset:832
    v_mfma_f32_16x16x32_bf16 v[48:51], v[140:143], v[80:83], v[48:51]
    ds_read_b64_tr_b16 v[124:125], v153 offset:96
    ds_read_b64_tr_b16 v[126:127], v153 offset:864
    v_mfma_f32_16x16x32_bf16 v[52:55], v[140:143], v[84:87], v[52:55]
    ds_read_b64_tr_b16 v[128:129], v152 offset:128
    ds_read_b64_tr_b16 v[130:131], v152 offset:896
    s_waitcnt lgkmcnt(6)
    v_mfma_f32_16x16x32_bf16 v[16:19], v[112:115], v[56:59], v[16:19]
    ds_read_b128 v[64:67], v147 offset:0
    ds_read_b128 v[68:71], v147 offset:2048
    v_mfma_f32_16x16x32_bf16 v[20:23], v[112:115], v[60:63], v[20:23]
    ds_read_b64_tr_b16 v[132:133], v152 offset:6144
    ds_read_b64_tr_b16 v[134:135], v152 offset:6912
    v_mfma_f32_16x16x32_bf16 v[24:27], v[116:119], v[56:59], v[24:27]
    ds_read_b64_tr_b16 v[136:137], v153 offset:6176
    ds_read_b64_tr_b16 v[138:139], v153 offset:6944
    v_mfma_f32_16x16x32_bf16 v[28:31], v[116:119], v[60:63], v[28:31]
    ds_read_b64_tr_b16 v[140:141], v152 offset:6208
    ds_read_b64_tr_b16 v[142:143], v152 offset:6976
    s_waitcnt lgkmcnt(10)
    v_mfma_f32_16x16x32_bf16 v[32:35], v[120:123], v[56:59], v[32:35]
    ds_read_b64_tr_b16 v[112:113], v153 offset:6240
    v_mfma_f32_16x16x32_bf16 v[36:39], v[120:123], v[60:63], v[36:39]
    ds_read_b64_tr_b16 v[114:115], v153 offset:7008
    v_mfma_f32_16x16x32_bf16 v[40:43], v[124:127], v[56:59], v[40:43]
    ds_read_b64_tr_b16 v[116:117], v152 offset:6272
    v_mfma_f32_16x16x32_bf16 v[44:47], v[124:127], v[60:63], v[44:47]
    ds_read_b64_tr_b16 v[118:119], v152 offset:7040
    s_waitcnt lgkmcnt(8)
    v_mfma_f32_16x16x32_bf16 v[48:51], v[128:131], v[56:59], v[48:51]
    v_mfma_f32_16x16x32_bf16 v[52:55], v[128:131], v[60:63], v[52:55]
    v_mfma_f32_16x16x32_bf16 v[16:19], v[132:135], v[64:67], v[16:19]
    v_mfma_f32_16x16x32_bf16 v[20:23], v[132:135], v[68:71], v[20:23]
    s_waitcnt lgkmcnt(4)
    v_mfma_f32_16x16x32_bf16 v[24:27], v[136:139], v[64:67], v[24:27]
    v_mfma_f32_16x16x32_bf16 v[28:31], v[136:139], v[68:71], v[28:31]
    s_waitcnt lgkmcnt(0)
    s_barrier
    v_mfma_f32_16x16x32_bf16 v[32:35], v[140:143], v[64:67], v[32:35]
    ds_read_b128 v[72:75], v148 offset:0
    ds_read_b128 v[76:79], v148 offset:2048
    v_mfma_f32_16x16x32_bf16 v[36:39], v[140:143], v[68:71], v[36:39]
    ds_read_b64_tr_b16 v[120:121], v154 offset:0
    ds_read_b64_tr_b16 v[122:123], v154 offset:768
    v_mfma_f32_16x16x32_bf16 v[40:43], v[112:115], v[64:67], v[40:43]
    ds_read_b64_tr_b16 v[124:125], v155 offset:32
    ds_read_b64_tr_b16 v[126:127], v155 offset:800
    v_mfma_f32_16x16x32_bf16 v[44:47], v[112:115], v[68:71], v[44:47]
    ds_read_b64_tr_b16 v[128:129], v154 offset:64
    ds_read_b64_tr_b16 v[130:131], v154 offset:832
    v_mfma_f32_16x16x32_bf16 v[48:51], v[116:119], v[64:67], v[48:51]
    ds_read_b64_tr_b16 v[132:133], v155 offset:96
    ds_read_b64_tr_b16 v[134:135], v155 offset:864
    v_mfma_f32_16x16x32_bf16 v[52:55], v[116:119], v[68:71], v[52:55]
    ds_read_b64_tr_b16 v[136:137], v154 offset:128
    ds_read_b64_tr_b16 v[138:139], v154 offset:896
    s_waitcnt lgkmcnt(6)
    v_mfma_f32_16x16x32_bf16 v[16:19], v[120:123], v[72:75], v[16:19]
    ds_read_b128 v[80:83], v149 offset:0
    ds_read_b128 v[84:87], v149 offset:2048
    v_mfma_f32_16x16x32_bf16 v[20:23], v[120:123], v[76:79], v[20:23]
    ds_read_b64_tr_b16 v[140:141], v154 offset:6144
    ds_read_b64_tr_b16 v[142:143], v154 offset:6912
    v_mfma_f32_16x16x32_bf16 v[24:27], v[124:127], v[72:75], v[24:27]
    ds_read_b64_tr_b16 v[112:113], v155 offset:6176
    ds_read_b64_tr_b16 v[114:115], v155 offset:6944
    v_mfma_f32_16x16x32_bf16 v[28:31], v[124:127], v[76:79], v[28:31]
    ds_read_b64_tr_b16 v[116:117], v154 offset:6208
    ds_read_b64_tr_b16 v[118:119], v154 offset:6976
    s_waitcnt lgkmcnt(10)
    v_mfma_f32_16x16x32_bf16 v[32:35], v[128:131], v[72:75], v[32:35]
    ds_read_b64_tr_b16 v[120:121], v155 offset:6240
    v_mfma_f32_16x16x32_bf16 v[36:39], v[128:131], v[76:79], v[36:39]
    ds_read_b64_tr_b16 v[122:123], v155 offset:7008
    v_mfma_f32_16x16x32_bf16 v[40:43], v[132:135], v[72:75], v[40:43]
    ds_read_b64_tr_b16 v[124:125], v154 offset:6272
    v_mfma_f32_16x16x32_bf16 v[44:47], v[132:135], v[76:79], v[44:47]
    ds_read_b64_tr_b16 v[126:127], v154 offset:7040
    s_waitcnt lgkmcnt(8)
    v_mfma_f32_16x16x32_bf16 v[48:51], v[136:139], v[72:75], v[48:51]
    v_mfma_f32_16x16x32_bf16 v[52:55], v[136:139], v[76:79], v[52:55]
    v_mfma_f32_16x16x32_bf16 v[16:19], v[140:143], v[80:83], v[16:19]
    v_mfma_f32_16x16x32_bf16 v[20:23], v[140:143], v[84:87], v[20:23]
    s_waitcnt lgkmcnt(4)
    v_mfma_f32_16x16x32_bf16 v[24:27], v[112:115], v[80:83], v[24:27]
    v_mfma_f32_16x16x32_bf16 v[28:31], v[112:115], v[84:87], v[28:31]
    s_waitcnt lgkmcnt(0)
    s_barrier
    v_mfma_f32_16x16x32_bf16 v[32:35], v[116:119], v[80:83], v[32:35]
    ds_read_b128 v[56:59], v144 offset:0
    ds_read_b128 v[60:63], v144 offset:2048
    v_mfma_f32_16x16x32_bf16 v[36:39], v[116:119], v[84:87], v[36:39]
    ds_read_b64_tr_b16 v[128:129], v150 offset:0
    ds_read_b64_tr_b16 v[130:131], v150 offset:768
    v_mfma_f32_16x16x32_bf16 v[40:43], v[120:123], v[80:83], v[40:43]
    ds_read_b64_tr_b16 v[132:133], v151 offset:32
    ds_read_b64_tr_b16 v[134:135], v151 offset:800
    v_mfma_f32_16x16x32_bf16 v[44:47], v[120:123], v[84:87], v[44:47]
    ds_read_b64_tr_b16 v[136:137], v150 offset:64
    ds_read_b64_tr_b16 v[138:139], v150 offset:832
    v_mfma_f32_16x16x32_bf16 v[48:51], v[124:127], v[80:83], v[48:51]
    ds_read_b64_tr_b16 v[140:141], v151 offset:96
    ds_read_b64_tr_b16 v[142:143], v151 offset:864
    v_mfma_f32_16x16x32_bf16 v[52:55], v[124:127], v[84:87], v[52:55]
    ds_read_b64_tr_b16 v[112:113], v150 offset:128
    ds_read_b64_tr_b16 v[114:115], v150 offset:896
    s_waitcnt lgkmcnt(6)
    v_mfma_f32_16x16x32_bf16 v[16:19], v[128:131], v[56:59], v[16:19]
    ds_read_b128 v[64:67], v145 offset:0
    ds_read_b128 v[68:71], v145 offset:2048
    v_mfma_f32_16x16x32_bf16 v[20:23], v[128:131], v[60:63], v[20:23]
    ds_read_b64_tr_b16 v[116:117], v150 offset:6144
    ds_read_b64_tr_b16 v[118:119], v150 offset:6912
    v_mfma_f32_16x16x32_bf16 v[24:27], v[132:135], v[56:59], v[24:27]
    ds_read_b64_tr_b16 v[120:121], v151 offset:6176
    ds_read_b64_tr_b16 v[122:123], v151 offset:6944
    v_mfma_f32_16x16x32_bf16 v[28:31], v[132:135], v[60:63], v[28:31]
    ds_read_b64_tr_b16 v[124:125], v150 offset:6208
    ds_read_b64_tr_b16 v[126:127], v150 offset:6976
    s_waitcnt lgkmcnt(10)
    v_mfma_f32_16x16x32_bf16 v[32:35], v[136:139], v[56:59], v[32:35]
    ds_read_b64_tr_b16 v[128:129], v151 offset:6240
    v_mfma_f32_16x16x32_bf16 v[36:39], v[136:139], v[60:63], v[36:39]
    ds_read_b64_tr_b16 v[130:131], v151 offset:7008
    v_mfma_f32_16x16x32_bf16 v[40:43], v[140:143], v[56:59], v[40:43]
    ds_read_b64_tr_b16 v[132:133], v150 offset:6272
    v_mfma_f32_16x16x32_bf16 v[44:47], v[140:143], v[60:63], v[44:47]
    ds_read_b64_tr_b16 v[134:135], v150 offset:7040
    s_waitcnt lgkmcnt(8)
    v_mfma_f32_16x16x32_bf16 v[48:51], v[112:115], v[56:59], v[48:51]
    v_mfma_f32_16x16x32_bf16 v[52:55], v[112:115], v[60:63], v[52:55]
    v_mfma_f32_16x16x32_bf16 v[16:19], v[116:119], v[64:67], v[16:19]
    v_mfma_f32_16x16x32_bf16 v[20:23], v[116:119], v[68:71], v[20:23]
    s_waitcnt lgkmcnt(4)
    v_mfma_f32_16x16x32_bf16 v[24:27], v[120:123], v[64:67], v[24:27]
    v_mfma_f32_16x16x32_bf16 v[28:31], v[120:123], v[68:71], v[28:31]
    s_waitcnt lgkmcnt(0)
    s_barrier
    v_mfma_f32_16x16x32_bf16 v[32:35], v[124:127], v[64:67], v[32:35]
    ds_read_b128 v[72:75], v146 offset:0
    ds_read_b128 v[76:79], v146 offset:2048
    v_mfma_f32_16x16x32_bf16 v[36:39], v[124:127], v[68:71], v[36:39]
    ds_read_b64_tr_b16 v[136:137], v152 offset:0
    ds_read_b64_tr_b16 v[138:139], v152 offset:768
    v_mfma_f32_16x16x32_bf16 v[40:43], v[128:131], v[64:67], v[40:43]
    ds_read_b64_tr_b16 v[140:141], v153 offset:32
    ds_read_b64_tr_b16 v[142:143], v153 offset:800
    v_mfma_f32_16x16x32_bf16 v[44:47], v[128:131], v[68:71], v[44:47]
    ds_read_b64_tr_b16 v[112:113], v152 offset:64
    ds_read_b64_tr_b16 v[114:115], v152 offset:832
    v_mfma_f32_16x16x32_bf16 v[48:51], v[132:135], v[64:67], v[48:51]
    ds_read_b64_tr_b16 v[116:117], v153 offset:96
    ds_read_b64_tr_b16 v[118:119], v153 offset:864
    v_mfma_f32_16x16x32_bf16 v[52:55], v[132:135], v[68:71], v[52:55]
    ds_read_b64_tr_b16 v[120:121], v152 offset:128
    ds_read_b64_tr_b16 v[122:123], v152 offset:896
    s_waitcnt lgkmcnt(6)
    v_mfma_f32_16x16x32_bf16 v[16:19], v[136:139], v[72:75], v[16:19]
    ds_read_b128 v[80:83], v147 offset:0
    ds_read_b128 v[84:87], v147 offset:2048
    v_mfma_f32_16x16x32_bf16 v[20:23], v[136:139], v[76:79], v[20:23]
    ds_read_b64_tr_b16 v[124:125], v152 offset:6144
    ds_read_b64_tr_b16 v[126:127], v152 offset:6912
    v_mfma_f32_16x16x32_bf16 v[24:27], v[140:143], v[72:75], v[24:27]
    ds_read_b64_tr_b16 v[128:129], v153 offset:6176
    ds_read_b64_tr_b16 v[130:131], v153 offset:6944
    v_mfma_f32_16x16x32_bf16 v[28:31], v[140:143], v[76:79], v[28:31]
    ds_read_b64_tr_b16 v[132:133], v152 offset:6208
    ds_read_b64_tr_b16 v[134:135], v152 offset:6976
    s_waitcnt lgkmcnt(10)
    v_mfma_f32_16x16x32_bf16 v[32:35], v[112:115], v[72:75], v[32:35]
    ds_read_b64_tr_b16 v[136:137], v153 offset:6240
    v_mfma_f32_16x16x32_bf16 v[36:39], v[112:115], v[76:79], v[36:39]
    ds_read_b64_tr_b16 v[138:139], v153 offset:7008
    v_mfma_f32_16x16x32_bf16 v[40:43], v[116:119], v[72:75], v[40:43]
    ds_read_b64_tr_b16 v[140:141], v152 offset:6272
    v_mfma_f32_16x16x32_bf16 v[44:47], v[116:119], v[76:79], v[44:47]
    ds_read_b64_tr_b16 v[142:143], v152 offset:7040
    s_waitcnt lgkmcnt(8)
    v_mfma_f32_16x16x32_bf16 v[48:51], v[120:123], v[72:75], v[48:51]
    v_mfma_f32_16x16x32_bf16 v[52:55], v[120:123], v[76:79], v[52:55]
    v_mfma_f32_16x16x32_bf16 v[16:19], v[124:127], v[80:83], v[16:19]
    v_mfma_f32_16x16x32_bf16 v[20:23], v[124:127], v[84:87], v[20:23]
    s_waitcnt lgkmcnt(4)
    v_mfma_f32_16x16x32_bf16 v[24:27], v[128:131], v[80:83], v[24:27]
    v_mfma_f32_16x16x32_bf16 v[28:31], v[128:131], v[84:87], v[28:31]
    s_waitcnt lgkmcnt(0)
    s_barrier
    v_mfma_f32_16x16x32_bf16 v[32:35], v[132:135], v[80:83], v[32:35]
    ds_read_b128 v[56:59], v148 offset:0
    ds_read_b128 v[60:63], v148 offset:2048
    v_mfma_f32_16x16x32_bf16 v[36:39], v[132:135], v[84:87], v[36:39]
    ds_read_b64_tr_b16 v[112:113], v154 offset:0
    ds_read_b64_tr_b16 v[114:115], v154 offset:768
    v_mfma_f32_16x16x32_bf16 v[40:43], v[136:139], v[80:83], v[40:43]
    ds_read_b64_tr_b16 v[116:117], v155 offset:32
    ds_read_b64_tr_b16 v[118:119], v155 offset:800
    v_mfma_f32_16x16x32_bf16 v[44:47], v[136:139], v[84:87], v[44:47]
    ds_read_b64_tr_b16 v[120:121], v154 offset:64
    ds_read_b64_tr_b16 v[122:123], v154 offset:832
    v_mfma_f32_16x16x32_bf16 v[48:51], v[140:143], v[80:83], v[48:51]
    ds_read_b64_tr_b16 v[124:125], v155 offset:96
    ds_read_b64_tr_b16 v[126:127], v155 offset:864
    v_mfma_f32_16x16x32_bf16 v[52:55], v[140:143], v[84:87], v[52:55]
    ds_read_b64_tr_b16 v[128:129], v154 offset:128
    ds_read_b64_tr_b16 v[130:131], v154 offset:896
    s_waitcnt lgkmcnt(6)
    v_mfma_f32_16x16x32_bf16 v[16:19], v[112:115], v[56:59], v[16:19]
    ds_read_b128 v[64:67], v149 offset:0
    ds_read_b128 v[68:71], v149 offset:2048
    v_mfma_f32_16x16x32_bf16 v[20:23], v[112:115], v[60:63], v[20:23]
    ds_read_b64_tr_b16 v[132:133], v154 offset:6144
    ds_read_b64_tr_b16 v[134:135], v154 offset:6912
    v_mfma_f32_16x16x32_bf16 v[24:27], v[116:119], v[56:59], v[24:27]
    ds_read_b64_tr_b16 v[136:137], v155 offset:6176
    ds_read_b64_tr_b16 v[138:139], v155 offset:6944
    v_mfma_f32_16x16x32_bf16 v[28:31], v[116:119], v[60:63], v[28:31]
    ds_read_b64_tr_b16 v[140:141], v154 offset:6208
    ds_read_b64_tr_b16 v[142:143], v154 offset:6976
    s_waitcnt lgkmcnt(10)
    v_mfma_f32_16x16x32_bf16 v[32:35], v[120:123], v[56:59], v[32:35]
    ds_read_b64_tr_b16 v[112:113], v155 offset:6240
    v_mfma_f32_16x16x32_bf16 v[36:39], v[120:123], v[60:63], v[36:39]
    ds_read_b64_tr_b16 v[114:115], v155 offset:7008
    v_mfma_f32_16x16x32_bf16 v[40:43], v[124:127], v[56:59], v[40:43]
    ds_read_b64_tr_b16 v[116:117], v154 offset:6272
    v_mfma_f32_16x16x32_bf16 v[44:47], v[124:127], v[60:63], v[44:47]
    ds_read_b64_tr_b16 v[118:119], v154 offset:7040
    s_waitcnt lgkmcnt(8)
    v_mfma_f32_16x16x32_bf16 v[48:51], v[128:131], v[56:59], v[48:51]
    v_mfma_f32_16x16x32_bf16 v[52:55], v[128:131], v[60:63], v[52:55]
    v_mfma_f32_16x16x32_bf16 v[16:19], v[132:135], v[64:67], v[16:19]
    v_mfma_f32_16x16x32_bf16 v[20:23], v[132:135], v[68:71], v[20:23]
    s_waitcnt lgkmcnt(4)
    v_mfma_f32_16x16x32_bf16 v[24:27], v[136:139], v[64:67], v[24:27]
    v_mfma_f32_16x16x32_bf16 v[28:31], v[136:139], v[68:71], v[28:31]
    s_waitcnt lgkmcnt(0)
    s_barrier
    v_mfma_f32_16x16x32_bf16 v[32:35], v[140:143], v[64:67], v[32:35]
    ds_read_b128 v[72:75], v144 offset:0
    ds_read_b128 v[76:79], v144 offset:2048
    v_mfma_f32_16x16x32_bf16 v[36:39], v[140:143], v[68:71], v[36:39]
    ds_read_b64_tr_b16 v[120:121], v150 offset:0
    ds_read_b64_tr_b16 v[122:123], v150 offset:768
    v_mfma_f32_16x16x32_bf16 v[40:43], v[112:115], v[64:67], v[40:43]
    ds_read_b64_tr_b16 v[124:125], v151 offset:32
    ds_read_b64_tr_b16 v[126:127], v151 offset:800
    v_mfma_f32_16x16x32_bf16 v[44:47], v[112:115], v[68:71], v[44:47]
    ds_read_b64_tr_b16 v[128:129], v150 offset:64
    ds_read_b64_tr_b16 v[130:131], v150 offset:832
    v_mfma_f32_16x16x32_bf16 v[48:51], v[116:119], v[64:67], v[48:51]
    ds_read_b64_tr_b16 v[132:133], v151 offset:96
    ds_read_b64_tr_b16 v[134:135], v151 offset:864
    v_mfma_f32_16x16x32_bf16 v[52:55], v[116:119], v[68:71], v[52:55]
    ds_read_b64_tr_b16 v[136:137], v150 offset:128
    ds_read_b64_tr_b16 v[138:139], v150 offset:896
    s_waitcnt lgkmcnt(6)
    v_mfma_f32_16x16x32_bf16 v[16:19], v[120:123], v[72:75], v[16:19]
    ds_read_b128 v[80:83], v145 offset:0
    ds_read_b128 v[84:87], v145 offset:2048
    v_mfma_f32_16x16x32_bf16 v[20:23], v[120:123], v[76:79], v[20:23]
    ds_read_b64_tr_b16 v[140:141], v150 offset:6144
    ds_read_b64_tr_b16 v[142:143], v150 offset:6912
    v_mfma_f32_16x16x32_bf16 v[24:27], v[124:127], v[72:75], v[24:27]
    ds_read_b64_tr_b16 v[112:113], v151 offset:6176
    ds_read_b64_tr_b16 v[114:115], v151 offset:6944
    v_mfma_f32_16x16x32_bf16 v[28:31], v[124:127], v[76:79], v[28:31]
    ds_read_b64_tr_b16 v[116:117], v150 offset:6208
    ds_read_b64_tr_b16 v[118:119], v150 offset:6976
    s_waitcnt lgkmcnt(10)
    v_mfma_f32_16x16x32_bf16 v[32:35], v[128:131], v[72:75], v[32:35]
    ds_read_b64_tr_b16 v[120:121], v151 offset:6240
    v_mfma_f32_16x16x32_bf16 v[36:39], v[128:131], v[76:79], v[36:39]
    ds_read_b64_tr_b16 v[122:123], v151 offset:7008
    v_mfma_f32_16x16x32_bf16 v[40:43], v[132:135], v[72:75], v[40:43]
    ds_read_b64_tr_b16 v[124:125], v150 offset:6272
    v_mfma_f32_16x16x32_bf16 v[44:47], v[132:135], v[76:79], v[44:47]
    ds_read_b64_tr_b16 v[126:127], v150 offset:7040
    s_waitcnt lgkmcnt(8)
    v_mfma_f32_16x16x32_bf16 v[48:51], v[136:139], v[72:75], v[48:51]
    v_mfma_f32_16x16x32_bf16 v[52:55], v[136:139], v[76:79], v[52:55]
    v_mfma_f32_16x16x32_bf16 v[16:19], v[140:143], v[80:83], v[16:19]
    v_mfma_f32_16x16x32_bf16 v[20:23], v[140:143], v[84:87], v[20:23]
    s_waitcnt lgkmcnt(4)
    v_mfma_f32_16x16x32_bf16 v[24:27], v[112:115], v[80:83], v[24:27]
    v_mfma_f32_16x16x32_bf16 v[28:31], v[112:115], v[84:87], v[28:31]
    v_mfma_f32_16x16x32_bf16 v[32:35], v[116:119], v[80:83], v[32:35]
    v_mfma_f32_16x16x32_bf16 v[36:39], v[116:119], v[84:87], v[36:39]
    s_waitcnt lgkmcnt(2)
    v_mfma_f32_16x16x32_bf16 v[40:43], v[120:123], v[80:83], v[40:43]
    ds_read_b64_tr_b16 v[164:165], v189 offset:0
    ds_read_b64_tr_b16 v[166:167], v189 offset:320
    v_mfma_f32_16x16x32_bf16 v[44:47], v[120:123], v[84:87], v[44:47]
    ds_read_b64_tr_b16 v[168:169], v189 offset:1280
    ds_read_b64_tr_b16 v[170:171], v189 offset:1600
    s_waitcnt lgkmcnt(0)
    v_mfma_f32_16x16x32_bf16 v[48:51], v[124:127], v[80:83], v[48:51]
    v_mfma_f32_16x16x32_bf16 v[52:55], v[124:127], v[84:87], v[52:55]
    ds_read_b64_tr_b16 v[172:173], v189 offset:2560
    ds_read_b64_tr_b16 v[174:175], v189 offset:2880
    ds_read_b64_tr_b16 v[176:177], v189 offset:64
    ds_read_b64_tr_b16 v[178:179], v189 offset:384
    ds_read_b64_tr_b16 v[180:181], v189 offset:1344
    ds_read_b64_tr_b16 v[182:183], v189 offset:1664
    ds_read_b64_tr_b16 v[184:185], v189 offset:2624
    ds_read_b64_tr_b16 v[186:187], v189 offset:2944
    s_nop 3
    v_cvt_pk_bf16_f32 v152, v32, v33
    v_cvt_pk_bf16_f32 v153, v34, v35
    v_cvt_pk_bf16_f32 v154, v36, v37
    v_cvt_pk_bf16_f32 v155, v38, v39
    s_nop 0
    v_permlane16_swap_b32 v152, v154
    v_permlane16_swap_b32 v153, v155
    ds_write_b128 v188, v[152:155] offset:0
    v_cvt_pk_bf16_f32 v156, v40, v41
    v_cvt_pk_bf16_f32 v157, v42, v43
    v_cvt_pk_bf16_f32 v158, v44, v45
    v_cvt_pk_bf16_f32 v159, v46, v47
    s_nop 0
    v_permlane16_swap_b32 v156, v158
    v_permlane16_swap_b32 v157, v159
    ds_write_b128 v188, v[156:159] offset:1024
    v_cvt_pk_bf16_f32 v144, v16, v17
    v_cvt_pk_bf16_f32 v145, v18, v19
    v_cvt_pk_bf16_f32 v146, v20, v21
    v_cvt_pk_bf16_f32 v147, v22, v23
    s_nop 0
    v_permlane16_swap_b32 v144, v146
    v_permlane16_swap_b32 v145, v147
    v_cvt_pk_bf16_f32 v148, v24, v25
    v_cvt_pk_bf16_f32 v149, v26, v27
    v_cvt_pk_bf16_f32 v150, v28, v29
    v_cvt_pk_bf16_f32 v151, v30, v31
    s_nop 0
    v_permlane16_swap_b32 v148, v150
    v_permlane16_swap_b32 v149, v151
    v_cvt_pk_bf16_f32 v160, v48, v49
    v_cvt_pk_bf16_f32 v161, v50, v51
    v_cvt_pk_bf16_f32 v162, v52, v53
    v_cvt_pk_bf16_f32 v163, v54, v55
    s_nop 0
    v_permlane16_swap_b32 v160, v162
    v_permlane16_swap_b32 v161, v163
    ds_write_b128 v188, v[160:163] offset:2048
    s_waitcnt lgkmcnt(0)
L_PHI:
    s_barrier
    s_cmp_eq_u32 s62, 0
    s_cbranch_scc1 NOHAND_46
    ds_read_b128 v[144:147], v188 offset:0
    ds_read_b128 v[148:151], v188 offset:1024
    ds_read_b128 v[152:155], v188 offset:2048
    s_waitcnt lgkmcnt(0)
NOHAND_46:
    v_mfma_f32_32x32x16_bf16 v[16:31], v[164:167], v[144:147], 0
    v_mfma_f32_32x32x16_bf16 v[16:31], v[168:171], v[148:151], v[16:31]
    v_mfma_f32_32x32x16_bf16 v[16:31], v[172:175], v[152:155], v[16:31]
    v_mfma_f32_32x32x16_bf16 v[32:47], v[176:179], v[144:147], 0
    v_mfma_f32_32x32x16_bf16 v[32:47], v[180:183], v[148:151], v[32:47]
    v_mfma_f32_32x32x16_bf16 v[32:47], v[184:187], v[152:155], v[32:47]
    s_nop 8
    v_max3_f32 v236, v16, v17, v18
    v_min3_f32 v237, v16, v17, v18
    v_max3_f32 v236, v236, v19, v20
    v_min3_f32 v237, v237, v19, v20
    v_max3_f32 v236, v236, v21, v22
    v_min3_f32 v237, v237, v21, v22
    v_max3_f32 v236, v236, v23, v24
    v_min3_f32 v237, v237, v23, v24
    v_max3_f32 v236, v236, v25, v26
    v_min3_f32 v237, v237, v25, v26
    v_max3_f32 v236, v236, v27, v28
    v_min3_f32 v237, v237, v27, v28
    v_max3_f32 v236, v236, v29, v30
    v_min3_f32 v237, v237, v29, v30
    v_max3_f32 v236, v236, v31, v32
    v_min3_f32 v237, v237, v31, v32
    v_max3_f32 v236, v236, v33, v34
    v_min3_f32 v237, v237, v33, v34
    s_mov_b32 s66, 0x3fb8aa3b
    v_max_f32 v236, v236, v35
    v_min_f32 v237, v237, v35
    v_mul_f32 v236, s66, v236
    v_mul_f32 v237, s66, v237
    v_mov_b32 v242, s66
    v_mov_b32 v243, s66
    v_pk_fma_f32 v[96:97], v[16:17], v[242:243], v[236:237] op_sel_hi:[1,1,0] neg_lo:[0,0,1] neg_hi:[0,0,1]
    v_pk_fma_f32 v[120:121], v[16:17], v[242:243], v[236:237] op_sel:[0,0,1] op_sel_hi:[1,1,1] neg_lo:[1,0,0] neg_hi:[1,0,0]
    v_pk_fma_f32 v[98:99], v[18:19], v[242:243], v[236:237] op_sel_hi:[1,1,0] neg_lo:[0,0,1] neg_hi:[0,0,1]
    v_pk_fma_f32 v[122:123], v[18:19], v[242:243], v[236:237] op_sel:[0,0,1] op_sel_hi:[1,1,1] neg_lo:[1,0,0] neg_hi:[1,0,0]
    v_pk_fma_f32 v[100:101], v[20:21], v[242:243], v[236:237] op_sel_hi:[1,1,0] neg_lo:[0,0,1] neg_hi:[0,0,1]
    v_pk_fma_f32 v[124:125], v[20:21], v[242:243], v[236:237] op_sel:[0,0,1] op_sel_hi:[1,1,1] neg_lo:[1,0,0] neg_hi:[1,0,0]
    v_pk_fma_f32 v[102:103], v[22:23], v[242:243], v[236:237] op_sel_hi:[1,1,0] neg_lo:[0,0,1] neg_hi:[0,0,1]
    v_pk_fma_f32 v[126:127], v[22:23], v[242:243], v[236:237] op_sel:[0,0,1] op_sel_hi:[1,1,1] neg_lo:[1,0,0] neg_hi:[1,0,0]
    v_pk_fma_f32 v[104:105], v[24:25], v[242:243], v[236:237] op_sel_hi:[1,1,0] neg_lo:[0,0,1] neg_hi:[0,0,1]
    v_pk_fma_f32 v[128:129], v[24:25], v[242:243], v[236:237] op_sel:[0,0,1] op_sel_hi:[1,1,1] neg_lo:[1,0,0] neg_hi:[1,0,0]
    v_pk_fma_f32 v[106:107], v[26:27], v[242:243], v[236:237] op_sel_hi:[1,1,0] neg_lo:[0,0,1] neg_hi:[0,0,1]
    v_pk_fma_f32 v[130:131], v[26:27], v[242:243], v[236:237] op_sel:[0,0,1] op_sel_hi:[1,1,1] neg_lo:[1,0,0] neg_hi:[1,0,0]
    v_pk_fma_f32 v[108:109], v[28:29], v[242:243], v[236:237] op_sel_hi:[1,1,0] neg_lo:[0,0,1] neg_hi:[0,0,1]
    v_pk_fma_f32 v[132:133], v[28:29], v[242:243], v[236:237] op_sel:[0,0,1] op_sel_hi:[1,1,1] neg_lo:[1,0,0] neg_hi:[1,0,0]
    v_pk_fma_f32 v[110:111], v[30:31], v[242:243], v[236:237] op_sel_hi:[1,1,0] neg_lo:[0,0,1] neg_hi:[0,0,1]
    v_pk_fma_f32 v[134:135], v[30:31], v[242:243], v[236:237] op_sel:[0,0,1] op_sel_hi:[1,1,1] neg_lo:[1,0,0] neg_hi:[1,0,0]
    v_pk_fma_f32 v[112:113], v[32:33], v[242:243], v[236:237] op_sel_hi:[1,1,0] neg_lo:[0,0,1] neg_hi:[0,0,1]
    v_pk_fma_f32 v[136:137], v[32:33], v[242:243], v[236:237] op_sel:[0,0,1] op_sel_hi:[1,1,1] neg_lo:[1,0,0] neg_hi:[1,0,0]
    v_pk_fma_f32 v[114:115], v[34:35], v[242:243], v[236:237] op_sel_hi:[1,1,0] neg_lo:[0,0,1] neg_hi:[0,0,1]
    v_pk_fma_f32 v[138:139], v[34:35], v[242:243], v[236:237] op_sel:[0,0,1] op_sel_hi:[1,1,1] neg_lo:[1,0,0] neg_hi:[1,0,0]
    v_exp_f32 v96, v96
    v_exp_f32 v120, v120
    v_exp_f32 v97, v97
    v_exp_f32 v121, v121
    v_exp_f32 v98, v98
    v_exp_f32 v122, v122
    v_exp_f32 v99, v99
    v_exp_f32 v123, v123
    v_exp_f32 v100, v100
    v_exp_f32 v124, v124
    v_exp_f32 v101, v101
    v_exp_f32 v125, v125
    v_pk_add_f32 v[238:239], v[96:97], v[98:99]
    v_pk_add_f32 v[240:241], v[120:121], v[122:123]
    v_exp_f32 v102, v102
    v_exp_f32 v126, v126
    v_exp_f32 v103, v103
    v_exp_f32 v127, v127
    v_pk_add_f32 v[238:239], v[238:239], v[100:101]
    v_pk_add_f32 v[240:241], v[240:241], v[124:125]
    v_exp_f32 v104, v104
    v_exp_f32 v128, v128
    v_exp_f32 v105, v105
    v_exp_f32 v129, v129
    v_pk_add_f32 v[238:239], v[238:239], v[102:103]
    v_pk_add_f32 v[240:241], v[240:241], v[126:127]
    v_exp_f32 v106, v106
    v_exp_f32 v130, v130
    v_exp_f32 v107, v107
    v_exp_f32 v131, v131
    v_pk_add_f32 v[238:239], v[238:239], v[104:105]
    v_pk_add_f32 v[240:241], v[240:241], v[128:129]
    v_exp_f32 v108, v108
    v_exp_f32 v132, v132
    v_exp_f32 v109, v109
    v_exp_f32 v133, v133
    v_pk_add_f32 v[238:239], v[238:239], v[106:107]
    v_pk_add_f32 v[240:241], v[240:241], v[130:131]
    v_exp_f32 v110, v110
    v_exp_f32 v134, v134
    v_exp_f32 v111, v111
    v_exp_f32 v135, v135
    v_pk_add_f32 v[238:239], v[238:239], v[108:109]
    v_pk_add_f32 v[240:241], v[240:241], v[132:133]
    v_exp_f32 v112, v112
    v_exp_f32 v136, v136
    v_exp_f32 v113, v113
    v_exp_f32 v137, v137
    v_pk_add_f32 v[238:239], v[238:239], v[110:111]
    v_pk_add_f32 v[240:241], v[240:241], v[134:135]
    v_exp_f32 v114, v114
    v_exp_f32 v138, v138
    v_exp_f32 v115, v115
    v_exp_f32 v139, v139
    v_pk_add_f32 v[238:239], v[238:239], v[112:113]
    v_pk_add_f32 v[240:241], v[240:241], v[136:137]
    s_nop 0
    v_pk_add_f32 v[238:239], v[238:239], v[114:115]
    v_pk_add_f32 v[240:241], v[240:241], v[138:139]
    v_add_f32 v238, v238, v239
    v_add_f32 v240, v240, v241
    v_rcp_f32 v238, v238
    v_rcp_f32 v240, v240
    s_nop 0
    v_pk_mul_f32 v[96:97], v[96:97], v[238:239] op_sel_hi:[1,0]
    v_pk_mul_f32 v[98:99], v[98:99], v[238:239] op_sel_hi:[1,0]
    v_cvt_pk_bf16_f32 v216, v96, v97
    v_cvt_pk_bf16_f32 v217, v98, v99
    v_pk_mul_f32 v[100:101], v[100:101], v[238:239] op_sel_hi:[1,0]
    v_pk_mul_f32 v[102:103], v[102:103], v[238:239] op_sel_hi:[1,0]
    v_cvt_pk_bf16_f32 v218, v100, v101
    v_cvt_pk_bf16_f32 v219, v102, v103
    v_pk_mul_f32 v[104:105], v[104:105], v[238:239] op_sel_hi:[1,0]
    v_pk_mul_f32 v[106:107], v[106:107], v[238:239] op_sel_hi:[1,0]
    v_cvt_pk_bf16_f32 v220, v104, v105
    v_cvt_pk_bf16_f32 v221, v106, v107
    v_pk_mul_f32 v[108:109], v[108:109], v[238:239] op_sel_hi:[1,0]
    v_pk_mul_f32 v[110:111], v[110:111], v[238:239] op_sel_hi:[1,0]
    v_cvt_pk_bf16_f32 v222, v108, v109
    v_cvt_pk_bf16_f32 v223, v110, v111
    v_pk_mul_f32 v[112:113], v[112:113], v[238:239] op_sel_hi:[1,0]
    v_pk_mul_f32 v[114:115], v[114:115], v[238:239] op_sel_hi:[1,0]
    v_cvt_pk_bf16_f32 v224, v112, v113
    v_cvt_pk_bf16_f32 v225, v114, v115
    v_pk_mul_f32 v[120:121], v[120:121], v[240:241] op_sel_hi:[1,0]
    v_pk_mul_f32 v[122:123], v[122:123], v[240:241] op_sel_hi:[1,0]
    v_cvt_pk_bf16_f32 v226, v120, v121
    v_cvt_pk_bf16_f32 v227, v122, v123
    v_pk_mul_f32 v[124:125], v[124:125], v[240:241] op_sel_hi:[1,0]
    v_pk_mul_f32 v[126:127], v[126:127], v[240:241] op_sel_hi:[1,0]
    v_cvt_pk_bf16_f32 v228, v124, v125
    v_cvt_pk_bf16_f32 v229, v126, v127
    v_pk_mul_f32 v[128:129], v[128:129], v[240:241] op_sel_hi:[1,0]
    v_pk_mul_f32 v[130:131], v[130:131], v[240:241] op_sel_hi:[1,0]
    v_cvt_pk_bf16_f32 v230, v128, v129
    v_cvt_pk_bf16_f32 v231, v130, v131
    v_pk_mul_f32 v[132:133], v[132:133], v[240:241] op_sel_hi:[1,0]
    v_pk_mul_f32 v[134:135], v[134:135], v[240:241] op_sel_hi:[1,0]
    v_cvt_pk_bf16_f32 v232, v132, v133
    v_cvt_pk_bf16_f32 v233, v134, v135
    v_pk_mul_f32 v[136:137], v[136:137], v[240:241] op_sel_hi:[1,0]
    v_pk_mul_f32 v[138:139], v[138:139], v[240:241] op_sel_hi:[1,0]
    v_cvt_pk_bf16_f32 v234, v136, v137
    v_cvt_pk_bf16_f32 v235, v138, v139
    s_cmp_ge_u32 s40, 6
    s_cbranch_scc1 L_NOWOQ
    s_lshr_b32 s58, s45, 2
    s_mul_i32 s58, s58, 160
    s_mul_i32 s59, s40, 40960
    s_add_u32 s58, s58, s59
    s_mul_i32 s59, s40, 5120
    s_add_u32 m0, s59, 36864
    s_nop 0
    buffer_load_dwordx4 v245, s[20:23], s58 offen offset:0 lds
    buffer_load_dwordx4 v246, s[20:23], s58 offen offset:1024 lds
    buffer_load_dwordx4 v247, s[20:23], s58 offen offset:2048 lds
    buffer_load_dwordx4 v248, s[20:23], s58 offen offset:3072 lds
    s_add_u32 m0, m0, 4096
    s_nop 0
    buffer_load_dwordx4 v249, s[20:23], s58 offen lds
    s_add_u32 m0, m0, 26624
    s_add_u32 s58, s58, 245760
    buffer_load_dwordx4 v245, s[20:23], s58 offen offset:0 lds
    buffer_load_dwordx4 v246, s[20:23], s58 offen offset:1024 lds
    buffer_load_dwordx4 v247, s[20:23], s58 offen offset:2048 lds
    buffer_load_dwordx4 v248, s[20:23], s58 offen offset:3072 lds
    s_add_u32 m0, m0, 4096
    s_nop 0
    buffer_load_dwordx4 v249, s[20:23], s58 offen lds
WOGE_48:
L_NOWOQ:
    v_mov_b32 v4, 0
    v_mov_b32 v5, 0
    v_lshlrev_b32 v2, 3, v1
    s_mov_b64 exec, 0xffff
    v_add_u32 v2, 162176, v2
    ds_write_b64 v2, v[4:5]
    s_mov_b64 exec, -1
    s_cmp_eq_u32 s40, 7
    s_cbranch_scc0 NOKVPOLL_49
    s_and_b32 s66, s44, 3
    s_lshl2_add_u32 s66, s42, s66
    s_lshl_b32 s66, s66, 8
    s_add_u32 s66, s66, 139264
    v_mov_b32 v2, 0
    s_mov_b32 s63, 131072
    s_mov_b64 exec, 1
    v_mov_b32 v252, 0
    buffer_atomic_add v252, v2, s[36:39], s66 offen sc0
    v_mov_b32 v253, 0
    buffer_atomic_add v253, v2, s[36:39], s66 offen sc0
PP_50:
    v_mov_b32 v254, 0
    buffer_atomic_add v254, v2, s[36:39], s66 offen sc0
    s_waitcnt vmcnt(2)
    v_readfirstlane_b32 s61, v252
    s_nop 0
    s_cmp_ge_u32 s61, 16
    s_cbranch_scc1 PPD_51
    v_mov_b32 v252, 0
    buffer_atomic_add v252, v2, s[36:39], s66 offen sc0
    s_waitcnt vmcnt(2)
    v_readfirstlane_b32 s61, v253
    s_nop 0
    s_cmp_ge_u32 s61, 16
    s_cbranch_scc1 PPD_51
    v_mov_b32 v253, 0
    buffer_atomic_add v253, v2, s[36:39], s66 offen sc0
    s_waitcnt vmcnt(2)
    v_readfirstlane_b32 s61, v254
    s_nop 0
    s_cmp_ge_u32 s61, 16
    s_cbranch_scc1 PPD_51
    s_sub_u32 s63, s63, 1
    s_cbranch_scc0 PP_50
PPD_51:
    s_mov_b64 exec, -1
NOKVPOLL_49:
    s_barrier
    buffer_load_dwordx4 v[16:19], v199, s[36:39], s7 offen sc1
    s_add_u32 s7, s7, 67584
    buffer_load_dwordx4 v[20:23], v199, s[36:39], s7 offen sc1
    v_cmp_gt_u32 vcc, 440, v0
    s_waitcnt vmcnt(1)
    v_lshlrev_b32 v32, 16, v16
    v_and_b32 v36, v200, v16
    v_lshlrev_b32 v33, 16, v17
    v_and_b32 v37, v200, v17
    v_lshlrev_b32 v34, 16, v18
    v_and_b32 v38, v200, v18
    v_lshlrev_b32 v35, 16, v19
    v_and_b32 v39, v200, v19
    s_waitcnt vmcnt(0)
    v_lshlrev_b32 v44, 16, v20
    v_and_b32 v48, v200, v20
    v_lshlrev_b32 v45, 16, v21
    v_and_b32 v49, v200, v21
    v_lshlrev_b32 v46, 16, v22
    v_and_b32 v50, v200, v22
    v_lshlrev_b32 v47, 16, v23
    v_and_b32 v51, v200, v23
    v_pk_add_f32 v[32:33], v[32:33], v[44:45]
    v_pk_add_f32 v[34:35], v[34:35], v[46:47]
    v_pk_add_f32 v[36:37], v[36:37], v[48:49]
    v_pk_add_f32 v[38:39], v[38:39], v[50:51]
    s_and_saveexec_b64 s[64:65], vcc
    v_cvt_pk_bf16_f32 v40, v32, v33
    v_cvt_pk_bf16_f32 v41, v34, v35
    v_cvt_pk_bf16_f32 v42, v36, v37
    v_cvt_pk_bf16_f32 v43, v38, v39
    ds_write_b64 v201, v[40:41]
    ds_write_b64 v201, v[42:43] offset:80
    s_mov_b64 exec, s[64:65]
    s_waitcnt lgkmcnt(0)
    s_barrier
    ds_read_b128 v[44:47], v203 offset:0
    ds_read_b128 v[48:51], v203 offset:16
    ds_read_b128 v[52:55], v203 offset:32
    ds_read_b128 v[56:59], v203 offset:48
    ds_read_b128 v[60:63], v203 offset:64
    ds_read_b128 v[24:27], v202 offset:0
    ds_read_b128 v[28:31], v202 offset:16
    ds_read_b128 v[32:35], v202 offset:32
    ds_read_b128 v[36:39], v202 offset:48
    ds_read_b128 v[40:43], v202 offset:64
    s_waitcnt lgkmcnt(9)
    v_mfma_f32_32x32x16_bf16 v[80:95], v[44:47], v[216:219], 0
    s_waitcnt lgkmcnt(8)
    v_mfma_f32_32x32x16_bf16 v[80:95], v[48:51], v[220:223], v[80:95]
    s_waitcnt lgkmcnt(7)
    v_mfma_f32_32x32x16_bf16 v[80:95], v[52:55], v[224:227], v[80:95]
    s_waitcnt lgkmcnt(6)
    v_mfma_f32_32x32x16_bf16 v[80:95], v[56:59], v[228:231], v[80:95]
    s_waitcnt lgkmcnt(5)
    v_mfma_f32_32x32x16_bf16 v[80:95], v[60:63], v[232:235], v[80:95]
    s_waitcnt lgkmcnt(4)
    v_mfma_f32_32x32x16_bf16 v[64:79], v[24:27], v[216:219], 0
    s_waitcnt lgkmcnt(3)
    v_mfma_f32_32x32x16_bf16 v[64:79], v[28:31], v[220:223], v[64:79]
    s_waitcnt lgkmcnt(2)
    v_mfma_f32_32x32x16_bf16 v[64:79], v[32:35], v[224:227], v[64:79]
    s_waitcnt lgkmcnt(1)
    v_mfma_f32_32x32x16_bf16 v[64:79], v[36:39], v[228:231], v[64:79]
    s_waitcnt lgkmcnt(0)
    v_mfma_f32_32x32x16_bf16 v[64:79], v[40:43], v[232:235], v[64:79]
    s_nop 2
    v_add_f32 v14, 0x358637bd, v84
    v_rcp_f32 v14, v14
    s_nop 0
    v_mul_f32 v80, v14, v80
    v_mul_f32 v81, v14, v81
    v_mul_f32 v82, v14, v82
    v_mul_f32 v83, v14, v83
    v_cvt_pk_bf16_f32 v104, v80, v81
    v_cvt_pk_bf16_f32 v105, v82, v83
    v_min_u32 v104, -2, v104
    buffer_store_dwordx2 v[104:105], v205, s[36:39], s54 offen sc1
    s_nop 0
    v_mul_f32 v64, v14, v64
    v_mul_f32 v65, v14, v65
    v_mul_f32 v66, v14, v66
    v_mul_f32 v67, v14, v67
    v_mul_f32 v68, v14, v68
    v_mul_f32 v69, v14, v69
    v_mul_f32 v70, v14, v70
    v_mul_f32 v71, v14, v71
    v_cvt_pk_bf16_f32 v96, v64, v65
    v_cvt_pk_bf16_f32 v97, v66, v67
    v_cvt_pk_bf16_f32 v98, v68, v69
    v_cvt_pk_bf16_f32 v99, v70, v71
    v_min_u32 v96, -2, v96
    buffer_store_dwordx4 v[96:99], v204, s[36:39], s46 offen offset:0 sc1
    v_mul_f32 v72, v14, v72
    v_mul_f32 v73, v14, v73
    v_mul_f32 v74, v14, v74
    v_mul_f32 v75, v14, v75
    v_mul_f32 v76, v14, v76
    v_mul_f32 v77, v14, v77
    v_mul_f32 v78, v14, v78
    v_mul_f32 v79, v14, v79
    v_cvt_pk_bf16_f32 v100, v72, v73
    v_cvt_pk_bf16_f32 v101, v74, v75
    v_cvt_pk_bf16_f32 v102, v76, v77
    v_cvt_pk_bf16_f32 v103, v78, v79
    v_min_u32 v100, -2, v100
    buffer_store_dwordx4 v[100:103], v204, s[36:39], s46 offen offset:1024 sc1
    s_barrier
    s_cmp_eq_u32 s40, 0
    s_cbranch_scc0 NOOSIG_52
    s_lshl_b32 s66, s41, 10
    s_add_u32 s66, s66, 147456
    v_lshlrev_b32 v2, 8, v1
    v_mov_b32 v3, 1
    s_mov_b64 exec, 15
    buffer_atomic_add v3, v2, s[36:39], s66 offen
    s_mov_b64 exec, -1
NOOSIG_52:
    s_cmp_eq_u32 s40, 1
    s_cbranch_scc0 NOOL_53
    v_mov_b32 v2, 0
    v_mov_b32 v252, 0
    s_mov_b64 exec, 1
    buffer_atomic_add v252, v2, s[36:39], s3 offen sc0
    s_mov_b64 exec, -1
NOOL_53:
    ds_read_b64_tr_b16 v[108:109], v211 offset:0
    ds_read_b64_tr_b16 v[110:111], v211 offset:640
    ds_read_b64_tr_b16 v[112:113], v211 offset:32
    ds_read_b64_tr_b16 v[114:115], v211 offset:672
    ds_read_b64_tr_b16 v[116:117], v211 offset:64
    ds_read_b64_tr_b16 v[118:119], v211 offset:704
    ds_read_b64_tr_b16 v[120:121], v211 offset:96
    ds_read_b64_tr_b16 v[122:123], v211 offset:736
    ds_read_b64_tr_b16 v[124:125], v211 offset:128
    ds_read_b64_tr_b16 v[126:127], v211 offset:768
    s_waitcnt lgkmcnt(5)
    ds_read_b64_tr_b16 v[128:129], v211 offset:6400
    ds_read_b64_tr_b16 v[130:131], v211 offset:7040
    ds_read_b64_tr_b16 v[132:133], v211 offset:6432
    ds_read_b64_tr_b16 v[134:135], v211 offset:7072
    ds_read_b64_tr_b16 v[136:137], v211 offset:6464
    ds_read_b64_tr_b16 v[138:139], v211 offset:7104
    ds_read_b64_tr_b16 v[140:141], v211 offset:6496
    ds_read_b64_tr_b16 v[142:143], v211 offset:7136
    ds_read_b64_tr_b16 v[144:145], v211 offset:6528
    ds_read_b64_tr_b16 v[146:147], v211 offset:7168
    s_waitcnt lgkmcnt(5)
    ds_read_b64_tr_b16 v[148:149], v211 offset:12800
    ds_read_b64_tr_b16 v[150:151], v211 offset:13440
    ds_read_b64_tr_b16 v[152:153], v211 offset:12832
    ds_read_b64_tr_b16 v[154:155], v211 offset:13472
    ds_read_b64_tr_b16 v[156:157], v211 offset:12864
    ds_read_b64_tr_b16 v[158:159], v211 offset:13504
    ds_read_b64_tr_b16 v[160:161], v211 offset:12896
    ds_read_b64_tr_b16 v[162:163], v211 offset:13536
    ds_read_b64_tr_b16 v[164:165], v211 offset:12928
    ds_read_b64_tr_b16 v[166:167], v211 offset:13568
L_FINAL:
    s_cmp_eq_u32 s40, 1
    s_cbranch_scc0 NOOPOLL_54
    v_mov_b32 v2, 0
    s_mov_b32 s63, 131072
    s_mov_b64 exec, 1
    v_mov_b32 v253, 0
    buffer_atomic_add v253, v2, s[36:39], s3 offen sc0
PP_55:
    v_mov_b32 v254, 0
    buffer_atomic_add v254, v2, s[36:39], s3 offen sc0
    s_waitcnt vmcnt(2)
    v_readfirstlane_b32 s61, v252
    s_nop 0
    s_cmp_ge_u32 s61, 8
    s_cbranch_scc1 PPD_56
    v_mov_b32 v252, 0
    buffer_atomic_add v252, v2, s[36:39], s3 offen sc0
    s_waitcnt vmcnt(2)
    v_readfirstlane_b32 s61, v253
    s_nop 0
    s_cmp_ge_u32 s61, 8
    s_cbranch_scc1 PPD_56
    v_mov_b32 v253, 0
    buffer_atomic_add v253, v2, s[36:39], s3 offen sc0
    s_waitcnt vmcnt(2)
    v_readfirstlane_b32 s61, v254
    s_nop 0
    s_cmp_ge_u32 s61, 8
    s_cbranch_scc1 PPD_56
    s_sub_u32 s63, s63, 1
    s_cbranch_scc0 PP_55
PPD_56:
    s_mov_b64 exec, -1
NOOPOLL_54:
    s_waitcnt lgkmcnt(0)
    s_barrier
    s_mov_b32 s63, 131072
L_OLOAD:
    buffer_load_dwordx4 v[16:19], v209, s[36:39], s5 offen offset:0 sc1
    buffer_load_dwordx4 v[20:23], v209, s[36:39], s5 offen offset:2048 sc1
    s_add_u32 s5, s5, 5120
    buffer_load_dwordx4 v[24:27], v209, s[36:39], s5 offen offset:0 sc1
    buffer_load_dwordx4 v[28:31], v209, s[36:39], s5 offen offset:2048 sc1
    ds_read_b64_tr_b16 v[168:169], v211 offset:19200
    ds_read_b64_tr_b16 v[170:171], v211 offset:19840
    ds_read_b64_tr_b16 v[172:173], v211 offset:19232
    ds_read_b64_tr_b16 v[174:175], v211 offset:19872
    ds_read_b64_tr_b16 v[176:177], v211 offset:19264
    ds_read_b64_tr_b16 v[178:179], v211 offset:19904
    ds_read_b64_tr_b16 v[180:181], v211 offset:19296
    ds_read_b64_tr_b16 v[182:183], v211 offset:19936
    ds_read_b64_tr_b16 v[184:185], v211 offset:19328
    ds_read_b64_tr_b16 v[186:187], v211 offset:19968
    s_waitcnt lgkmcnt(5)
    ds_read_b64_tr_b16 v[188:189], v211 offset:25600
    ds_read_b64_tr_b16 v[190:191], v211 offset:26240
    ds_read_b64_tr_b16 v[192:193], v211 offset:25632
    ds_read_b64_tr_b16 v[194:195], v211 offset:26272
    ds_read_b64_tr_b16 v[196:197], v211 offset:25664
    ds_read_b64_tr_b16 v[198:199], v211 offset:26304
    ds_read_b64_tr_b16 v[200:201], v211 offset:25696
    ds_read_b64_tr_b16 v[202:203], v211 offset:26336
    ds_read_b64_tr_b16 v[204:205], v211 offset:25728
    ds_read_b64_tr_b16 v[206:207], v211 offset:26368
    s_waitcnt vmcnt(3)
    v_mov_b32 v106, v16
    v_mfma_f32_16x16x32_bf16 v[56:59], v[108:111], v[16:19], 0
    s_add_u32 s5, s5, 5120
    buffer_load_dwordx4 v[32:35], v209, s[36:39], s5 offen offset:0 sc1
    v_mfma_f32_16x16x32_bf16 v[60:63], v[112:115], v[16:19], 0
    v_mfma_f32_16x16x32_bf16 v[64:67], v[116:119], v[16:19], 0
    v_mfma_f32_16x16x32_bf16 v[68:71], v[120:123], v[16:19], 0
    v_mfma_f32_16x16x32_bf16 v[72:75], v[124:127], v[16:19], 0
    s_waitcnt vmcnt(3) lgkmcnt(0)
    v_max_u32 v106, v106, v20
    v_mfma_f32_16x16x32_bf16 v[56:59], v[128:131], v[20:23], v[56:59]
    buffer_load_dwordx4 v[36:39], v209, s[36:39], s5 offen offset:2048 sc1
    ds_read_b64_tr_b16 v[108:109], v211 offset:32000
    ds_read_b64_tr_b16 v[110:111], v211 offset:32640
    v_mfma_f32_16x16x32_bf16 v[60:63], v[132:135], v[20:23], v[60:63]
    ds_read_b64_tr_b16 v[112:113], v211 offset:32032
    ds_read_b64_tr_b16 v[114:115], v211 offset:32672
    v_mfma_f32_16x16x32_bf16 v[64:67], v[136:139], v[20:23], v[64:67]
    ds_read_b64_tr_b16 v[116:117], v211 offset:32064
    ds_read_b64_tr_b16 v[118:119], v211 offset:32704
    v_mfma_f32_16x16x32_bf16 v[68:71], v[140:143], v[20:23], v[68:71]
    ds_read_b64_tr_b16 v[120:121], v211 offset:32096
    ds_read_b64_tr_b16 v[122:123], v211 offset:32736
    v_mfma_f32_16x16x32_bf16 v[72:75], v[144:147], v[20:23], v[72:75]
    ds_read_b64_tr_b16 v[124:125], v211 offset:32128
    ds_read_b64_tr_b16 v[126:127], v211 offset:32768
    s_waitcnt vmcnt(3) lgkmcnt(5)
    v_max_u32 v106, v106, v24
    v_mfma_f32_16x16x32_bf16 v[56:59], v[148:151], v[24:27], v[56:59]
    s_add_u32 s5, s5, 5120
    buffer_load_dwordx4 v[40:43], v209, s[36:39], s5 offen offset:0 sc1
    ds_read_b64_tr_b16 v[128:129], v211 offset:38400
    ds_read_b64_tr_b16 v[130:131], v211 offset:39040
    v_mfma_f32_16x16x32_bf16 v[60:63], v[152:155], v[24:27], v[60:63]
    ds_read_b64_tr_b16 v[132:133], v211 offset:38432
    ds_read_b64_tr_b16 v[134:135], v211 offset:39072
    v_mfma_f32_16x16x32_bf16 v[64:67], v[156:159], v[24:27], v[64:67]
    ds_read_b64_tr_b16 v[136:137], v211 offset:38464
    ds_read_b64_tr_b16 v[138:139], v211 offset:39104
    v_mfma_f32_16x16x32_bf16 v[68:71], v[160:163], v[24:27], v[68:71]
    ds_read_b64_tr_b16 v[140:141], v211 offset:38496
    ds_read_b64_tr_b16 v[142:143], v211 offset:39136
    v_mfma_f32_16x16x32_bf16 v[72:75], v[164:167], v[24:27], v[72:75]
    ds_read_b64_tr_b16 v[144:145], v211 offset:38528
    ds_read_b64_tr_b16 v[146:147], v211 offset:39168
    s_waitcnt vmcnt(3) lgkmcnt(5)
    v_max_u32 v106, v106, v28
    v_mfma_f32_16x16x32_bf16 v[56:59], v[168:171], v[28:31], v[56:59]
    buffer_load_dwordx4 v[44:47], v209, s[36:39], s5 offen offset:2048 sc1
    ds_read_b64_tr_b16 v[148:149], v211 offset:44800
    ds_read_b64_tr_b16 v[150:151], v211 offset:45440
    v_mfma_f32_16x16x32_bf16 v[60:63], v[172:175], v[28:31], v[60:63]
    ds_read_b64_tr_b16 v[152:153], v211 offset:44832
    ds_read_b64_tr_b16 v[154:155], v211 offset:45472
    v_mfma_f32_16x16x32_bf16 v[64:67], v[176:179], v[28:31], v[64:67]
    ds_read_b64_tr_b16 v[156:157], v211 offset:44864
    ds_read_b64_tr_b16 v[158:159], v211 offset:45504
    v_mfma_f32_16x16x32_bf16 v[68:71], v[180:183], v[28:31], v[68:71]
    ds_read_b64_tr_b16 v[160:161], v211 offset:44896
    ds_read_b64_tr_b16 v[162:163], v211 offset:45536
    v_mfma_f32_16x16x32_bf16 v[72:75], v[184:187], v[28:31], v[72:75]
    ds_read_b64_tr_b16 v[164:165], v211 offset:44928
    ds_read_b64_tr_b16 v[166:167], v211 offset:45568
    s_waitcnt vmcnt(3) lgkmcnt(5)
    v_max_u32 v106, v106, v32
    v_mfma_f32_16x16x32_bf16 v[56:59], v[188:191], v[32:35], v[56:59]
    buffer_load_dwordx2 v[48:49], v210, s[36:39], s4 offen offset:0 sc1
    buffer_load_dwordx2 v[50:51], v210, s[36:39], s4 offen offset:512 sc1
    ds_read_b64_tr_b16 v[168:169], v212 offset:0
    ds_read_b64_tr_b16 v[170:171], v212 offset:6400
    v_mfma_f32_16x16x32_bf16 v[60:63], v[192:195], v[32:35], v[60:63]
    ds_read_b64_tr_b16 v[172:173], v212 offset:32
    ds_read_b64_tr_b16 v[174:175], v212 offset:6432
    v_mfma_f32_16x16x32_bf16 v[64:67], v[196:199], v[32:35], v[64:67]
    ds_read_b64_tr_b16 v[176:177], v212 offset:64
    ds_read_b64_tr_b16 v[178:179], v212 offset:6464
    v_mfma_f32_16x16x32_bf16 v[68:71], v[200:203], v[32:35], v[68:71]
    ds_read_b64_tr_b16 v[180:181], v212 offset:96
    ds_read_b64_tr_b16 v[182:183], v212 offset:6496
    v_mfma_f32_16x16x32_bf16 v[72:75], v[204:207], v[32:35], v[72:75]
    ds_read_b64_tr_b16 v[184:185], v212 offset:128
    ds_read_b64_tr_b16 v[186:187], v212 offset:6528
    s_waitcnt vmcnt(4) lgkmcnt(5)
    v_max_u32 v106, v106, v36
    v_mfma_f32_16x16x32_bf16 v[56:59], v[108:111], v[36:39], v[56:59]
    s_add_u32 s4, s4, 10240
    buffer_load_dwordx2 v[52:53], v210, s[36:39], s4 offen offset:0 sc1
    buffer_load_dwordx2 v[54:55], v210, s[36:39], s4 offen offset:512 sc1
    ds_read_b64_tr_b16 v[188:189], v212 offset:25600
    ds_read_b64_tr_b16 v[190:191], v212 offset:32000
    v_mfma_f32_16x16x32_bf16 v[60:63], v[112:115], v[36:39], v[60:63]
    ds_read_b64_tr_b16 v[192:193], v212 offset:25632
    ds_read_b64_tr_b16 v[194:195], v212 offset:32032
    v_mfma_f32_16x16x32_bf16 v[64:67], v[116:119], v[36:39], v[64:67]
    ds_read_b64_tr_b16 v[196:197], v212 offset:25664
    ds_read_b64_tr_b16 v[198:199], v212 offset:32064
    v_mfma_f32_16x16x32_bf16 v[68:71], v[120:123], v[36:39], v[68:71]
    ds_read_b64_tr_b16 v[200:201], v212 offset:25696
    ds_read_b64_tr_b16 v[202:203], v212 offset:32096
    v_mfma_f32_16x16x32_bf16 v[72:75], v[124:127], v[36:39], v[72:75]
    ds_read_b64_tr_b16 v[204:205], v212 offset:25728
    ds_read_b64_tr_b16 v[206:207], v212 offset:32128
    s_waitcnt vmcnt(5)
    v_max_u32 v106, v106, v40
    v_mfma_f32_16x16x32_bf16 v[56:59], v[128:131], v[40:43], v[56:59]
    v_mfma_f32_16x16x32_bf16 v[60:63], v[132:135], v[40:43], v[60:63]
    v_mfma_f32_16x16x32_bf16 v[64:67], v[136:139], v[40:43], v[64:67]
    v_mfma_f32_16x16x32_bf16 v[68:71], v[140:143], v[40:43], v[68:71]
    v_mfma_f32_16x16x32_bf16 v[72:75], v[144:147], v[40:43], v[72:75]
    s_waitcnt vmcnt(4)
    v_max_u32 v106, v106, v44
    v_mfma_f32_16x16x32_bf16 v[56:59], v[148:151], v[44:47], v[56:59]
    v_mfma_f32_16x16x32_bf16 v[60:63], v[152:155], v[44:47], v[60:63]
    v_mfma_f32_16x16x32_bf16 v[64:67], v[156:159], v[44:47], v[64:67]
    v_mfma_f32_16x16x32_bf16 v[68:71], v[160:163], v[44:47], v[68:71]
    v_mfma_f32_16x16x32_bf16 v[72:75], v[164:167], v[44:47], v[72:75]
    s_waitcnt vmcnt(2) lgkmcnt(10)
    v_max3_u32 v106, v106, v48, v50
    v_mfma_f32_16x16x32_bf16 v[56:59], v[168:171], v[48:51], v[56:59]
    v_mfma_f32_16x16x32_bf16 v[60:63], v[172:175], v[48:51], v[60:63]
    v_mfma_f32_16x16x32_bf16 v[64:67], v[176:179], v[48:51], v[64:67]
    v_mfma_f32_16x16x32_bf16 v[68:71], v[180:183], v[48:51], v[68:71]
    v_mfma_f32_16x16x32_bf16 v[72:75], v[184:187], v[48:51], v[72:75]
    s_waitcnt vmcnt(0) lgkmcnt(0)
    v_max3_u32 v106, v106, v52, v54
    v_mfma_f32_16x16x32_bf16 v[56:59], v[188:191], v[52:55], v[56:59]
    v_mfma_f32_16x16x32_bf16 v[60:63], v[192:195], v[52:55], v[60:63]
    v_mfma_f32_16x16x32_bf16 v[64:67], v[196:199], v[52:55], v[64:67]
    v_mfma_f32_16x16x32_bf16 v[68:71], v[200:203], v[52:55], v[68:71]
    v_mfma_f32_16x16x32_bf16 v[72:75], v[204:207], v[52:55], v[72:75]
    v_cmp_eq_u32 vcc, -1, v106
    s_nop 0
    s_cbranch_vccnz L_ORETRY
L_OOK:
    s_cmp_eq_u32 s62, 0
    s_cbranch_scc0 FINHI_57
    s_nop 3
    ds_write_b128 v214, v[64:67] offset:2048
    ds_write_b128 v214, v[68:71] offset:3072
    s_waitcnt lgkmcnt(0)
    s_barrier
    ds_read_b128 v[76:79], v214 offset:0
    ds_read_b128 v[80:83], v214 offset:1024
    ds_read_b128 v[92:95], v214 offset:4096
    s_waitcnt lgkmcnt(2)
    v_pk_add_f32 v[56:57], v[56:57], v[76:77]
    v_pk_add_f32 v[58:59], v[58:59], v[78:79]
    v_cvt_pk_bf16_f32 v96, v56, v57
    v_cvt_pk_bf16_f32 v97, v58, v59
    s_waitcnt lgkmcnt(1)
    v_pk_add_f32 v[60:61], v[60:61], v[80:81]
    v_pk_add_f32 v[62:63], v[62:63], v[82:83]
    v_cvt_pk_bf16_f32 v98, v60, v61
    v_cvt_pk_bf16_f32 v99, v62, v63
    s_nop 1
    v_permlane16_swap_b32 v96, v98
    v_permlane16_swap_b32 v97, v99
    buffer_store_dwordx4 v[96:99], v215, s[28:31], s6 offen offset:0
    s_waitcnt lgkmcnt(0)
    v_pk_add_f32 v[72:73], v[72:73], v[92:93]
    v_pk_add_f32 v[74:75], v[74:75], v[94:95]
    v_cvt_pk_bf16_f32 v100, v72, v73
    v_cvt_pk_bf16_f32 v101, v74, v75
    buffer_store_dwordx2 v[100:101], v213, s[28:31], s6 offen offset:128
    s_branch L_FINI
FINHI_57:
    s_nop 3
    ds_write_b128 v214, v[56:59] offset:0
    ds_write_b128 v214, v[60:63] offset:1024
    ds_write_b128 v214, v[72:75] offset:4096
    s_waitcnt lgkmcnt(0)
    s_barrier
    ds_read_b128 v[84:87], v214 offset:2048
    ds_read_b128 v[88:91], v214 offset:3072
    s_waitcnt lgkmcnt(1)
    v_pk_add_f32 v[64:65], v[64:65], v[84:85]
    v_pk_add_f32 v[66:67], v[66:67], v[86:87]
    v_cvt_pk_bf16_f32 v96, v64, v65
    v_cvt_pk_bf16_f32 v97, v66, v67
    s_waitcnt lgkmcnt(0)
    v_pk_add_f32 v[68:69], v[68:69], v[88:89]
    v_pk_add_f32 v[70:71], v[70:71], v[90:91]
    v_cvt_pk_bf16_f32 v98, v68, v69
    v_cvt_pk_bf16_f32 v99, v70, v71
    s_nop 1
    v_permlane16_swap_b32 v96, v98
    v_permlane16_swap_b32 v97, v99
    buffer_store_dwordx4 v[96:99], v215, s[28:31], s6 offen offset:64
    s_branch L_FINI
L_ORETRY:
    s_sub_u32 s63, s63, 1
    s_cbranch_scc1 L_OOK
    s_sub_u32 s5, s5, 15360
    s_sub_u32 s4, s4, 10240
    s_nop 7
    ds_read_b64_tr_b16 v[108:109], v211 offset:0
    ds_read_b64_tr_b16 v[110:111], v211 offset:640
    ds_read_b64_tr_b16 v[112:113], v211 offset:32
    ds_read_b64_tr_b16 v[114:115], v211 offset:672
    ds_read_b64_tr_b16 v[116:117], v211 offset:64
    ds_read_b64_tr_b16 v[118:119], v211 offset:704
    ds_read_b64_tr_b16 v[120:121], v211 offset:96
    ds_read_b64_tr_b16 v[122:123], v211 offset:736
    ds_read_b64_tr_b16 v[124:125], v211 offset:128
    ds_read_b64_tr_b16 v[126:127], v211 offset:768
    s_waitcnt lgkmcnt(5)
    ds_read_b64_tr_b16 v[128:129], v211 offset:6400
    ds_read_b64_tr_b16 v[130:131], v211 offset:7040
    ds_read_b64_tr_b16 v[132:133], v211 offset:6432
    ds_read_b64_tr_b16 v[134:135], v211 offset:7072
    ds_read_b64_tr_b16 v[136:137], v211 offset:6464
    ds_read_b64_tr_b16 v[138:139], v211 offset:7104
    ds_read_b64_tr_b16 v[140:141], v211 offset:6496
    ds_read_b64_tr_b16 v[142:143], v211 offset:7136
    ds_read_b64_tr_b16 v[144:145], v211 offset:6528
    ds_read_b64_tr_b16 v[146:147], v211 offset:7168
    s_waitcnt lgkmcnt(5)
    ds_read_b64_tr_b16 v[148:149], v211 offset:12800
    ds_read_b64_tr_b16 v[150:151], v211 offset:13440
    ds_read_b64_tr_b16 v[152:153], v211 offset:12832
    ds_read_b64_tr_b16 v[154:155], v211 offset:13472
    ds_read_b64_tr_b16 v[156:157], v211 offset:12864
    ds_read_b64_tr_b16 v[158:159], v211 offset:13504
    ds_read_b64_tr_b16 v[160:161], v211 offset:12896
    ds_read_b64_tr_b16 v[162:163], v211 offset:13536
    ds_read_b64_tr_b16 v[164:165], v211 offset:12928
    ds_read_b64_tr_b16 v[166:167], v211 offset:13568
    s_waitcnt lgkmcnt(0)
    s_branch L_OLOAD
L_FINI:
L_END:
    s_endpgm
L_TEXTEND:
.section .rodata,"a"
.p2align 6
.amdhsa_kernel concat_heads__linear_kernel_hedgehog__spectral_fnet__prompt_kernel
  .amdhsa_next_free_vgpr 256
  .amdhsa_next_free_sgpr 102
  .amdhsa_accum_offset 256
  .amdhsa_group_segment_fixed_size 0
  .amdhsa_kernarg_size 96
  .amdhsa_user_sgpr_count 2
  .amdhsa_user_sgpr_kernarg_segment_ptr 1
  .amdhsa_system_sgpr_workgroup_id_x 1
.end_amdhsa_kernel
```
